```python
import torch

def _softmax(x, axis=-1):
    return torch.softmax(x, dim=axis)
def _gelu(x):
    return torch.nn.functional.gelu(x, approximate="tanh")
def _silu(x):
    return torch.nn.functional.silu(x)
def _sigmoid(x):
    return torch.sigmoid(x)
def _layernorm(x, axis=-1, eps=1e-5):
    m = x.mean(dim=axis, keepdim=True)
    v = x.var(dim=axis, keepdim=True, unbiased=False)
    return (x - m) / torch.sqrt(v + eps)
def _scatter_add(tgt, idx, src, axis=0):
    return tgt.clone().index_add_(axis, idx, src)
def _segment_sum(src, seg, n):
    out = torch.zeros((n,) + src.shape[1:], dtype=src.dtype)
    return out.index_add_(0, seg, src)
def _pad(x, pw):
    flat = tuple(v for pair in reversed(pw) for v in pair)
    return torch.nn.functional.pad(x, flat)

kernel_name = 'recurrent_scan__softmax_full_mha__swiglu_ffn__prompt'

def setup_inputs():

    _w = (lambda a: (lambda t: t.to(torch.bfloat16) if t.is_floating_point() else t)(torch.as_tensor(a)))
    def _A_setup():
        B, S, D = 1, 2048, 640
        return {
            "x": _w((lambda *s: torch.randn(*s, dtype=torch.bfloat16) * 0.05)(B, S, D)),
            "wqkv": _w((lambda *s: torch.randn(*s, dtype=torch.bfloat16) * 0.05)(D, 3 * D)),
            "wo": _w((lambda *s: torch.randn(*s, dtype=torch.bfloat16) * 0.05)(D, D)),
        }
    _A_in = _A_setup()

    def _B_setup():
        B, S, D, F = 1, 2048, 640, 1536
        return {
            "x": _w((lambda *s: torch.randn(*s, dtype=torch.bfloat16) * 0.05)(B, S, D)),
            "w_gate": _w((lambda *s: torch.randn(*s, dtype=torch.bfloat16) * 0.05)(D, F)),
            "w_up": _w((lambda *s: torch.randn(*s, dtype=torch.bfloat16) * 0.05)(D, F)),
            "w_down": _w((lambda *s: torch.randn(*s, dtype=torch.bfloat16) * 0.05)(F, D)),
        }
    _B_in = _B_setup()

    return {
        "A_x": _A_in["x"],
        "A_wqkv": _A_in["wqkv"],
        "A_wo": _A_in["wo"],
        "B_x": _B_in["x"],
        "B_w_gate": _B_in["w_gate"],
        "B_w_up": _B_in["w_up"],
        "B_w_down": _B_in["w_down"],
    }

def reference(A_x, A_wqkv, A_wo, B_x, B_w_gate, B_w_up, B_w_down):
    def _A_ref(x, wqkv, wo):
        B, S, D = x.shape
        H = 32; Dh = D // H
        qkv = (lambda x, *d: x.permute(*d))((x @ wqkv).reshape(B, S, 3, H, Dh), 2, 0, 3, 1, 4)
        q, k, v = qkv[0], qkv[1], qkv[2]
        scale = Dh ** -0.5
        scores = torch.einsum("bhqd,bhkd->bhqk", q, k) * scale
        p = _softmax(scores, axis=-1)
        o = torch.einsum("bhqk,bhkd->bhqd", p, v)
        return (lambda x, *d: x.permute(*d))(o, 0, 2, 1, 3).reshape(B, S, D) @ wo

    def _B_ref(x, w_gate, w_up, w_down):
        g = _silu(x @ w_gate)
        u = x @ w_up
        return (g * u) @ w_down

    x = A_x
    xn = _layernorm(x, axis=-1)
    s = _A_ref(xn, A_wqkv, A_wo)
    g = _silu(_B_ref(xn, B_w_gate, B_w_up, B_w_down))
    return x + s * g
```

```asm
; @launch grid=(256,1,1) block=(768,1,1) lds=162080
.amdgcn_target "amdgcn-amd-amdhsa--gfx950"
.text
.globl recurrent_scan__softmax_full_mha__swiglu_ffn__prompt_kernel
.p2align 8
.type recurrent_scan__softmax_full_mha__swiglu_ffn__prompt_kernel,@function
recurrent_scan__softmax_full_mha__swiglu_ffn__prompt_kernel:
    s_cmp_ge_u32 s2, 256
    s_cbranch_scc1 L_end
    s_load_dwordx16 s[4:19], s[0:1], 0
    s_load_dwordx4 s[20:23], s[0:1], 64
    v_lshrrev_b32 v1, 6, v0
    s_and_b32 s58, s2, 7
    v_readfirstlane_b32 s3, v1
    v_and_b32 v0, 63, v0
    s_setprio 3
    s_cmp_ge_u32 s3, 4
    s_cbranch_scc1 L_ids
    s_cmp_lg_u32 s3, 0
    s_cbranch_scc1 L_nocode
    s_getpc_b64 s[60:61]
L_pc:
    s_and_b32 s62, s2, 0xf8
    v_lshrrev_b32 v1, 4, v0
    v_mad_u32_u24 v1, v1, s62, v0
    v_lshlrev_b32 v1, 7, v1
    v_min_u32 v1, L_codeend-L_pc-4, v1
    v_mov_b32 v3, s61
    v_add_co_u32 v2, vcc, s60, v1
    s_mov_b64 exec, 0xffffff
    s_nop 0
    v_addc_co_u32 v3, vcc, 0, v3, vcc
    global_load_dword v167, v[2:3], off
    s_mov_b64 exec, -1
L_nocode:
    s_setprio 0
L_ids:
    s_lshr_b32 s59, s2, 3
    s_and_b32 s60, s58, 4
    s_lshl_b32 s60, s60, 1
    s_and_b32 s61, s59, 7
    s_add_u32 s52, s60, s61
    s_and_b32 s60, s58, 3
    s_lshl_b32 s60, s60, 1
    s_lshr_b32 s61, s59, 4
    s_add_u32 s60, s60, s61
    s_lshl_b32 s61, s60, 2
    s_mov_b32 s60, 0xc7549310
    s_and_b32 s62, s59, 8
    s_cselect_b32 s60, 0xfdb6ea82, s60
    s_lshr_b32 s61, s60, s61
    s_and_b32 s53, s61, 15
    s_lshl_b32 s58, s53, 1
    s_add_u32 s59, s53, 8
    s_xor_b32 s59, s59, 4
    s_add_u32 s58, s58, 1
    s_cmp_lt_u32 s53, 8
    s_cselect_b32 s54, s58, s59
    s_sub_u32 s59, s53, 8
    s_mul_i32 s59, s59, 3
    s_xor_b32 s58, s58, 1
    s_add_u32 s60, s59, 1
    s_add_u32 s61, s59, 2
    s_add_u32 s62, s53, 20
    s_add_u32 s63, s53, 14
    s_min_u32 s59, s59, 19
    s_cmp_lt_u32 s53, 14
    s_cselect_b32 s61, s61, s63
    s_cmp_lt_u32 s53, 8
    s_cselect_b32 s55, s58, s59
    s_cselect_b32 s56, s58, s60
    s_cselect_b32 s57, s62, s61
    s_cmp_lt_u32 s3, 8
    s_cbranch_scc1 L1_compute
    s_sub_u32 s58, s3, 8
    v_lshrrev_b32 v7, 3, v0
    v_lshrrev_b32 v8, 4, v0
    v_and_b32 v9, 7, v0
    v_xor_b32 v8, v8, v9
    v_lshlrev_b32 v8, 4, v8
    v_mul_u32_u24 v23, 1280, v7
    v_add_u32 v23, v23, v8
    v_xor_b32 v24, 64, v23
    v_lshrrev_b32 v7, 5, v0
    v_bfe_u32 v8, v0, 2, 2
    v_lshl_add_u32 v7, v7, 2, v8
    v_bfe_u32 v8, v0, 4, 1
    v_and_b32 v9, 3, v0
    v_lshlrev_b32 v9, 4, v9
    v_lshl_add_u32 v8, v8, 6, v9
    v_mul_u32_u24 v25, 1280, v7
    v_add_u32 v25, v25, v8
    s_cmp_lt_u32 s53, 8
    s_movk_i32 s62, 3840
    s_cselect_b32 s62, 3072, s62
    s_lshl_b32 s64, s58, 3
    v_add_u32 v7, s64, v7
    s_and_b32 s64, s58, 1
    s_lshl_b32 s64, s64, 5
    v_xor_b32 v8, s64, v8
    v_mul_u32_u24 v21, 3840, v7
    v_add_u32 v21, v21, v8
    v_mad_u32_u24 v22, s62, v7, v8
    s_lshl_b32 s59, s55, 7
    s_lshl_b32 s60, s56, 7
    s_lshl_b32 s61, s57, 7
    s_cmp_ge_u32 s53, 14
    s_cselect_b32 s60, 1073741824, s60
    s_lshl_b32 s63, s52, 2
    s_add_u32 s63, s63, s58
    s_lshl_b32 s69, s58, 10
    s_mul_i32 s42, s62, 640
    s_mov_b32 s43, 0x00020000
    s_mov_b32 s46, s42
    s_mov_b32 s47, 0x00020000
    s_lshl_b32 s62, s62, 5
    s_mov_b32 s30, 2621440
    s_mov_b32 s31, 0x00020000
    s_mov_b32 s50, 2457600
    s_mov_b32 s51, 0x00020000
    s_cmp_lt_u32 s53, 8
    s_waitcnt lgkmcnt(0)
    s_mov_b64 s[28:29], s[4:5]
    s_mov_b64 s[48:49], s[6:7]
    s_cselect_b64 s[40:41], s[12:13], s[48:49]
    s_cselect_b64 s[44:45], s[14:15], s[48:49]
    s_mul_i32 s4, s63, 40960
    s_lshl_b32 s5, s58, 12
    s_add_u32 m0, s5, 0
    s_add_u32 s20, s4, 0
    buffer_load_dwordx4 v23, s[28:31], s20 offen  lds
    s_add_u32 m0, s5, 1024
    s_add_u32 s20, s4, 10240
    buffer_load_dwordx4 v24, s[28:31], s20 offen  lds
    s_add_u32 m0, s5, 2048
    s_add_u32 s20, s4, 20480
    buffer_load_dwordx4 v23, s[28:31], s20 offen  lds
    s_add_u32 m0, s5, 3072
    s_add_u32 s20, s4, 30720
    buffer_load_dwordx4 v24, s[28:31], s20 offen  lds
    s_add_u32 m0, s69, 98304
    s_nop 0
    buffer_load_dwordx4 v22, s[40:43], s59 offen  lds
    s_add_u32 m0, s69, 102400
    s_add_u32 s59, s59, s62
    buffer_load_dwordx4 v22, s[44:47], s60 offen  lds
    s_add_u32 m0, s69, 106496
    s_add_u32 s60, s60, s62
    buffer_load_dwordx4 v21, s[48:51], s61 offen  lds
    s_add_u32 s61, s61, 122880
    s_add_u32 m0, s69, 110592
    s_nop 0
    buffer_load_dwordx4 v22, s[40:43], s59 offen  lds
    s_add_u32 m0, s69, 114688
    s_add_u32 s59, s59, s62
    buffer_load_dwordx4 v22, s[44:47], s60 offen  lds
    s_add_u32 m0, s69, 118784
    s_add_u32 s60, s60, s62
    buffer_load_dwordx4 v21, s[48:51], s61 offen  lds
    s_add_u32 s61, s61, 122880
    s_add_u32 m0, s5, 16384
    s_add_u32 s20, s4, 128
    buffer_load_dwordx4 v23, s[28:31], s20 offen  lds
    s_add_u32 m0, s5, 17408
    s_add_u32 s20, s4, 10368
    buffer_load_dwordx4 v24, s[28:31], s20 offen  lds
    s_mov_b32 s32, s12
    s_mov_b32 s33, s13
    s_mov_b32 s34, 1966080
    s_mov_b32 s35, 0x00020000
    s_mov_b32 s36, s14
    s_mov_b32 s37, s15
    s_mov_b32 s38, 1966080
    s_mov_b32 s39, 0x00020000
    s_mov_b32 s24, s22
    s_mov_b32 s25, s23
    s_mov_b32 s26, 22675456
    s_mov_b32 s27, 0x00020000
    s_lshl_b32 s68, s54, 7
    v_mul_u32_u24 v20, 3072, v7
    v_add_u32 v20, v20, v8
    v_mov_b32 v10, 162048
    s_mov_b64 s[64:65], s[16:17]
    s_mov_b64 s[66:67], s[8:9]
    v_lshrrev_b32 v43, 5, v0
    s_mov_b32 s11, 0
    v_lshrrev_b32 v8, 4, v0
    v_lshlrev_b32 v26, 10, v8
    v_xor_b32 v8, s11, v8
    v_and_b32 v8, 1, v8
    v_lshl_add_u32 v26, v8, 5, v26
    v_bfe_u32 v8, v0, 2, 2
    v_lshl_add_u32 v26, v8, 6, v26
    v_and_b32 v8, 3, v0
    v_lshl_add_u32 v26, v8, 3, v26
    s_lshr_b32 s10, s11, 1
    s_lshl_b32 s10, s10, 8
    v_add_u32 v26, s10, v26
    s_mul_i32 s10, s58, 12288
    s_add_u32 s10, s10, 106496
    v_add_u32 v26, s10, v26
    v_xor_b32 v27, 32, v26
    s_and_b32 s11, s2, 7
    s_lshr_b32 s10, s2, 3
    s_and_b32 s7, s10, 7
    s_and_b32 s14, s10, 3
    s_lshr_b32 s13, s10, 2
    s_lshl_b32 s6, s11, 3
    s_add_u32 s13, s13, s6
    s_lshr_b32 s10, s10, 3
    s_lshl_b32 s11, s11, 2
    s_add_u32 s6, s11, s10
    s_and_b32 s8, s6, 1
    s_lshr_b32 s11, s6, 1
    s_mul_i32 s11, s11, 5
    s_add_u32 s12, s11, 2
    s_mul_i32 s10, s8, 3
    s_add_u32 s9, s11, s10
    s_and_b32 s16, s3, 3
    s_mul_i32 s15, s14, 10
    s_add_u32 s15, s15, s16
    s_mul_i32 s15, s15, 20
    s_lshr_b32 s11, s3, 2
    s_mul_i32 s11, s11, 6
    s_add_u32 s15, s15, s11
    s_lshl_b32 s15, s15, 10
    s_add_u32 s15, s15, 21364736
    s_mul_i32 s17, s13, 40960
    s_mul_i32 s11, s14, 320
    s_add_u32 s17, s17, s11
    v_lshlrev_b32 v2, 4, v0
    v_mul_u32_u24 v3, 81920, v43
    v_and_b32 v4, 0x1ff, v2
    v_add_u32 v3, v3, v4
    v_and_b32 v7, 15, v0
    v_lshrrev_b32 v8, 4, v0
    v_lshlrev_b32 v16, 9, v8
    v_lshl_add_u32 v16, v7, 4, v16
    v_mul_u32_u24 v1, 656, v7
    v_lshl_add_u32 v1, v8, 4, v1
    s_mul_i32 s11, s58, 20992
    s_add_u32 s11, s11, 67584
    v_add_u32 v1, s11, v1
    s_mul_i32 s10, s6, 20
    v_add_u32 v6, 0, v0
    v_mul_u32_u24 v7, 3277, v6
    v_lshrrev_b32 v7, 16, v7
    v_mul_u32_u24 v8, 20, v7
    v_sub_u32 v6, v6, v8
    v_add_u32 v6, s10, v6
    v_lshrrev_b32 v8, 4, v6
    v_and_b32 v6, 15, v6
    v_lshlrev_b32 v6, 4, v6
    v_lshl_add_u32 v6, v8, 16, v6
    v_lshl_add_u32 v13, v7, 8, v6
    v_add_u32 v6, 64, v0
    v_mul_u32_u24 v7, 3277, v6
    v_lshrrev_b32 v7, 16, v7
    v_mul_u32_u24 v8, 20, v7
    v_sub_u32 v6, v6, v8
    v_add_u32 v6, s10, v6
    v_lshrrev_b32 v8, 4, v6
    v_and_b32 v6, 15, v6
    v_lshlrev_b32 v6, 4, v6
    v_lshl_add_u32 v6, v8, 16, v6
    v_lshl_add_u32 v14, v7, 8, v6
    v_add_u32 v6, 128, v0
    v_mul_u32_u24 v7, 3277, v6
    v_lshrrev_b32 v7, 16, v7
    v_mul_u32_u24 v8, 20, v7
    v_sub_u32 v6, v6, v8
    v_add_u32 v6, s10, v6
    v_lshrrev_b32 v8, 4, v6
    v_and_b32 v6, 15, v6
    v_lshlrev_b32 v6, 4, v6
    v_lshl_add_u32 v6, v8, 16, v6
    v_lshl_add_u32 v15, v7, 8, v6
    v_bfe_u32 v6, v0, 4, 1
    v_mul_u32_u24 v6, 19, v6
    v_add_u32 v6, s10, v6
    v_lshrrev_b32 v6, 6, v6
    v_mul_u32_u24 v12, 86, v6
    v_lshrrev_b32 v12, 8, v12
    v_add_lshl_u32 v12, v12, 8, 4
    v_and_b32 v8, 1, v0
    v_lshl_add_u32 v8, s7, 1, v8
    v_add_lshl_u32 v12, v12, v8, 7
    v_add_u32 v7, 10, v6
    v_mul_u32_u24 v7, 86, v7
    v_lshrrev_b32 v7, 8, v7
    v_add_u32 v8, 7, v6
    v_lshrrev_b32 v8, 4, v8
    v_add3_u32 v7, v7, v8, 8
    v_add_u32 v8, 6, v6
    v_cmp_gt_u32 vcc, 8, v6
    s_nop 1
    v_cndmask_b32 v6, v8, v6, vcc
    v_cmp_gt_u32 vcc, 32, v0
    v_and_b32 v8, 15, v0
    s_nop 0
    v_cndmask_b32 v6, v6, v7, vcc
    v_lshl_add_u32 v6, v6, 4, v8
    v_lshlrev_b32 v6, 7, v6
    v_lshlrev_b32 v7, 7, v0
    s_lshl_b32 s11, s53, 4
    s_add_u32 s11, s11, s52
    s_lshl_b32 s11, s11, 7
    s_add_u32 s11, s11, 22183936
    v_mov_b32 v11, s11
    s_setprio 3
    s_waitcnt vmcnt(5)
    s_barrier
    s_add_u32 m0, s5, 18432
    s_add_u32 s20, s4, 20608
    buffer_load_dwordx4 v23, s[28:31], s20 offen  lds
    s_add_u32 m0, s5, 19456
    s_add_u32 s20, s4, 30848
    buffer_load_dwordx4 v24, s[28:31], s20 offen  lds
    s_add_u32 m0, s69, 122880
    s_nop 0
    buffer_load_dwordx4 v22, s[40:43], s59 offen  lds
    s_add_u32 m0, s69, 126976
    s_add_u32 s59, s59, s62
    buffer_load_dwordx4 v22, s[44:47], s60 offen  lds
    s_add_u32 m0, s69, 131072
    s_add_u32 s60, s60, s62
    buffer_load_dwordx4 v21, s[48:51], s61 offen  lds
    s_add_u32 s61, s61, 122880
    s_add_u32 m0, s5, 32768
    s_add_u32 s20, s4, 256
    buffer_load_dwordx4 v23, s[28:31], s20 offen  lds
    s_waitcnt vmcnt(8)
    s_barrier
    s_add_u32 m0, s5, 33792
    s_add_u32 s20, s4, 10496
    buffer_load_dwordx4 v24, s[28:31], s20 offen  lds
    s_add_u32 m0, s69, 135168
    s_nop 0
    buffer_load_dwordx4 v22, s[40:43], s59 offen  lds
    s_add_u32 m0, s69, 139264
    s_add_u32 s59, s59, s62
    buffer_load_dwordx4 v22, s[44:47], s60 offen  lds
    s_add_u32 m0, s69, 143360
    s_add_u32 s60, s60, s62
    buffer_load_dwordx4 v21, s[48:51], s61 offen  lds
    s_add_u32 s61, s61, 122880
    s_add_u32 m0, s5, 34816
    s_add_u32 s20, s4, 20736
    buffer_load_dwordx4 v23, s[28:31], s20 offen  lds
    s_add_u32 m0, s5, 35840
    s_add_u32 s20, s4, 30976
    buffer_load_dwordx4 v24, s[28:31], s20 offen  lds
    s_waitcnt vmcnt(7)
    s_barrier
    s_add_u32 m0, s69, 147456
    s_nop 0
    buffer_load_dwordx4 v22, s[40:43], s59 offen  lds
    s_add_u32 m0, s69, 151552
    s_add_u32 s59, s59, s62
    buffer_load_dwordx4 v22, s[44:47], s60 offen  lds
    s_add_u32 m0, s69, 155648
    s_add_u32 s60, s60, s62
    buffer_load_dwordx4 v21, s[48:51], s61 offen  lds
    s_add_u32 s61, s61, 122880
    s_add_u32 m0, s5, 49152
    s_add_u32 s20, s4, 384
    buffer_load_dwordx4 v23, s[28:31], s20 offen  lds
    s_add_u32 m0, s5, 50176
    s_add_u32 s20, s4, 10624
    buffer_load_dwordx4 v24, s[28:31], s20 offen  lds
    s_add_u32 m0, s69, 98304
    s_nop 0
    buffer_load_dwordx4 v22, s[40:43], s59 offen  lds
    s_waitcnt vmcnt(8)
    s_barrier
    s_add_u32 m0, s69, 102400
    s_add_u32 s59, s59, s62
    buffer_load_dwordx4 v22, s[44:47], s60 offen  lds
    s_add_u32 m0, s69, 106496
    s_add_u32 s60, s60, s62
    buffer_load_dwordx4 v21, s[48:51], s61 offen  lds
    s_add_u32 s61, s61, 122880
    s_add_u32 m0, s5, 51200
    s_add_u32 s20, s4, 20864
    buffer_load_dwordx4 v23, s[28:31], s20 offen  lds
    s_add_u32 m0, s5, 52224
    s_add_u32 s20, s4, 31104
    buffer_load_dwordx4 v24, s[28:31], s20 offen  lds
    s_add_u32 m0, s69, 110592
    s_nop 0
    buffer_load_dwordx4 v22, s[40:43], s59 offen  lds
    s_add_u32 m0, s69, 114688
    s_add_u32 s59, s59, s62
    buffer_load_dwordx4 v22, s[44:47], s60 offen  lds
    s_waitcnt vmcnt(9)
    s_barrier
    s_add_u32 m0, s69, 118784
    s_add_u32 s60, s60, s62
    buffer_load_dwordx4 v21, s[48:51], s61 offen  lds
    s_add_u32 s61, s61, 122880
    s_add_u32 m0, s5, 65536
    s_add_u32 s20, s4, 512
    buffer_load_dwordx4 v23, s[28:31], s20 offen  lds
    s_add_u32 m0, s5, 66560
    s_add_u32 s20, s4, 10752
    buffer_load_dwordx4 v24, s[28:31], s20 offen  lds
    s_add_u32 m0, s69, 122880
    s_nop 0
    buffer_load_dwordx4 v22, s[40:43], s59 offen  lds
    s_add_u32 m0, s69, 126976
    s_add_u32 s59, s59, s62
    buffer_load_dwordx4 v22, s[44:47], s60 offen  lds
    s_add_u32 m0, s69, 131072
    s_add_u32 s60, s60, s62
    buffer_load_dwordx4 v21, s[48:51], s61 offen  lds
    s_add_u32 s61, s61, 122880
    s_waitcnt vmcnt(10)
    s_barrier
    s_add_u32 m0, s5, 67584
    s_add_u32 s20, s4, 20992
    buffer_load_dwordx4 v23, s[28:31], s20 offen  lds
    s_add_u32 m0, s5, 68608
    s_add_u32 s20, s4, 31232
    buffer_load_dwordx4 v24, s[28:31], s20 offen  lds
    s_add_u32 m0, s69, 135168
    s_nop 0
    buffer_load_dwordx4 v22, s[40:43], s59 offen  lds
    s_add_u32 m0, s69, 139264
    s_add_u32 s59, s59, s62
    buffer_load_dwordx4 v22, s[44:47], s60 offen  lds
    s_add_u32 m0, s69, 143360
    s_add_u32 s60, s60, s62
    buffer_load_dwordx4 v21, s[48:51], s61 offen  lds
    s_add_u32 s61, s61, 122880
    s_waitcnt vmcnt(10)
    s_barrier
    s_add_u32 m0, s5, 81920
    s_add_u32 s20, s4, 640
    buffer_load_dwordx4 v23, s[28:31], s20 offen  lds
    s_add_u32 m0, s5, 82944
    s_add_u32 s20, s4, 10880
    buffer_load_dwordx4 v24, s[28:31], s20 offen  lds
    s_add_u32 m0, s69, 147456
    s_nop 0
    buffer_load_dwordx4 v22, s[40:43], s59 offen  lds
    s_add_u32 m0, s69, 151552
    s_add_u32 s59, s59, s62
    buffer_load_dwordx4 v22, s[44:47], s60 offen  lds
    s_add_u32 m0, s69, 155648
    s_add_u32 s60, s60, s62
    buffer_load_dwordx4 v21, s[48:51], s61 offen  lds
    s_add_u32 s61, s61, 122880
    s_waitcnt vmcnt(10)
    s_barrier
    s_add_u32 m0, s5, 83968
    s_add_u32 s20, s4, 21120
    buffer_load_dwordx4 v23, s[28:31], s20 offen  lds
    s_add_u32 m0, s5, 84992
    s_add_u32 s20, s4, 31360
    buffer_load_dwordx4 v24, s[28:31], s20 offen  lds
    s_add_u32 m0, s69, 98304
    s_nop 0
    buffer_load_dwordx4 v22, s[40:43], s59 offen  lds
    s_add_u32 m0, s69, 102400
    s_add_u32 s59, s59, s62
    buffer_load_dwordx4 v22, s[44:47], s60 offen  lds
    s_add_u32 m0, s69, 106496
    s_add_u32 s60, s60, s62
    buffer_load_dwordx4 v21, s[48:51], s61 offen  lds
    s_add_u32 s61, s61, 122880
    s_waitcnt vmcnt(10)
    s_barrier
    s_add_u32 m0, s5, 0
    s_add_u32 s20, s4, 768
    buffer_load_dwordx4 v23, s[28:31], s20 offen  lds
    s_add_u32 m0, s5, 1024
    s_add_u32 s20, s4, 11008
    buffer_load_dwordx4 v24, s[28:31], s20 offen  lds
    s_add_u32 m0, s69, 110592
    s_nop 0
    buffer_load_dwordx4 v22, s[40:43], s59 offen  lds
    s_add_u32 m0, s69, 114688
    s_add_u32 s59, s59, s62
    buffer_load_dwordx4 v22, s[44:47], s60 offen  lds
    s_add_u32 m0, s69, 118784
    s_add_u32 s60, s60, s62
    buffer_load_dwordx4 v21, s[48:51], s61 offen  lds
    s_add_u32 s61, s61, 122880
    s_waitcnt vmcnt(10)
    s_barrier
    s_add_u32 m0, s5, 2048
    s_add_u32 s20, s4, 21248
    buffer_load_dwordx4 v23, s[28:31], s20 offen  lds
    s_add_u32 m0, s5, 3072
    s_add_u32 s20, s4, 31488
    buffer_load_dwordx4 v24, s[28:31], s20 offen  lds
    s_add_u32 m0, s69, 122880
    s_nop 0
    buffer_load_dwordx4 v22, s[40:43], s59 offen  lds
    s_add_u32 m0, s69, 126976
    s_add_u32 s59, s59, s62
    buffer_load_dwordx4 v22, s[44:47], s60 offen  lds
    s_add_u32 m0, s69, 131072
    s_add_u32 s60, s60, s62
    buffer_load_dwordx4 v21, s[48:51], s61 offen  lds
    s_add_u32 s61, s61, 122880
    s_waitcnt vmcnt(10)
    s_barrier
    s_add_u32 m0, s5, 16384
    s_add_u32 s20, s4, 896
    buffer_load_dwordx4 v23, s[28:31], s20 offen  lds
    s_add_u32 m0, s5, 17408
    s_add_u32 s20, s4, 11136
    buffer_load_dwordx4 v24, s[28:31], s20 offen  lds
    s_add_u32 m0, s69, 135168
    s_nop 0
    buffer_load_dwordx4 v22, s[40:43], s59 offen  lds
    s_add_u32 m0, s69, 139264
    s_add_u32 s59, s59, s62
    buffer_load_dwordx4 v22, s[44:47], s60 offen  lds
    s_add_u32 m0, s69, 143360
    s_add_u32 s60, s60, s62
    buffer_load_dwordx4 v21, s[48:51], s61 offen  lds
    s_add_u32 s61, s61, 122880
    s_waitcnt vmcnt(10)
    s_barrier
    s_add_u32 m0, s5, 18432
    s_add_u32 s20, s4, 21376
    buffer_load_dwordx4 v23, s[28:31], s20 offen  lds
    s_add_u32 m0, s5, 19456
    s_add_u32 s20, s4, 31616
    buffer_load_dwordx4 v24, s[28:31], s20 offen  lds
    s_add_u32 m0, s69, 147456
    s_nop 0
    buffer_load_dwordx4 v22, s[40:43], s59 offen  lds
    s_add_u32 m0, s69, 151552
    s_add_u32 s59, s59, s62
    buffer_load_dwordx4 v22, s[44:47], s60 offen  lds
    s_add_u32 m0, s69, 155648
    s_add_u32 s60, s60, s62
    buffer_load_dwordx4 v21, s[48:51], s61 offen  lds
    s_add_u32 s61, s61, 122880
    s_waitcnt vmcnt(10)
    s_barrier
    s_add_u32 m0, s5, 32768
    s_add_u32 s20, s4, 1024
    buffer_load_dwordx4 v23, s[28:31], s20 offen  lds
    s_add_u32 m0, s5, 33792
    s_add_u32 s20, s4, 11264
    buffer_load_dwordx4 v24, s[28:31], s20 offen  lds
    s_add_u32 m0, s69, 98304
    s_nop 0
    buffer_load_dwordx4 v22, s[40:43], s59 offen  lds
    s_add_u32 m0, s69, 102400
    s_add_u32 s59, s59, s62
    buffer_load_dwordx4 v22, s[44:47], s60 offen  lds
    s_add_u32 m0, s69, 106496
    s_add_u32 s60, s60, s62
    buffer_load_dwordx4 v21, s[48:51], s61 offen  lds
    s_add_u32 s61, s61, 122880
    s_waitcnt vmcnt(10)
    s_barrier
    s_add_u32 m0, s5, 34816
    s_add_u32 s20, s4, 21504
    buffer_load_dwordx4 v23, s[28:31], s20 offen  lds
    s_add_u32 m0, s5, 35840
    s_add_u32 s20, s4, 31744
    buffer_load_dwordx4 v24, s[28:31], s20 offen  lds
    s_add_u32 m0, s69, 110592
    s_nop 0
    buffer_load_dwordx4 v22, s[40:43], s59 offen  lds
    s_add_u32 m0, s69, 114688
    s_add_u32 s59, s59, s62
    buffer_load_dwordx4 v22, s[44:47], s60 offen  lds
    s_add_u32 m0, s69, 118784
    s_add_u32 s60, s60, s62
    buffer_load_dwordx4 v21, s[48:51], s61 offen  lds
    s_add_u32 s61, s61, 122880
    s_waitcnt vmcnt(10)
    s_barrier
    s_add_u32 m0, s5, 49152
    s_add_u32 s20, s4, 1152
    buffer_load_dwordx4 v23, s[28:31], s20 offen  lds
    s_add_u32 m0, s5, 50176
    s_add_u32 s20, s4, 11392
    buffer_load_dwordx4 v24, s[28:31], s20 offen  lds
    s_add_u32 m0, s69, 122880
    s_nop 0
    buffer_load_dwordx4 v22, s[40:43], s59 offen  lds
    s_add_u32 m0, s69, 126976
    s_add_u32 s59, s59, s62
    buffer_load_dwordx4 v22, s[44:47], s60 offen  lds
    s_add_u32 m0, s69, 131072
    s_add_u32 s60, s60, s62
    buffer_load_dwordx4 v21, s[48:51], s61 offen  lds
    s_add_u32 s61, s61, 122880
    s_waitcnt vmcnt(10)
    s_barrier
    s_add_u32 m0, s5, 51200
    s_add_u32 s20, s4, 21632
    buffer_load_dwordx4 v23, s[28:31], s20 offen  lds
    s_add_u32 m0, s5, 52224
    s_add_u32 s20, s4, 31872
    buffer_load_dwordx4 v24, s[28:31], s20 offen  lds
    s_add_u32 m0, s69, 135168
    s_nop 0
    buffer_load_dwordx4 v22, s[40:43], s59 offen  lds
    s_add_u32 m0, s69, 139264
    s_add_u32 s59, s59, s62
    buffer_load_dwordx4 v22, s[44:47], s60 offen  lds
    s_add_u32 m0, s69, 143360
    s_add_u32 s60, s60, s62
    buffer_load_dwordx4 v21, s[48:51], s61 offen  lds
    s_add_u32 s61, s61, 122880
    s_waitcnt vmcnt(10)
    s_barrier
    s_add_u32 m0, s69, 147456
    s_nop 0
    buffer_load_dwordx4 v22, s[40:43], s59 offen  lds
    s_add_u32 m0, s69, 151552
    s_add_u32 s59, s59, s62
    buffer_load_dwordx4 v22, s[44:47], s60 offen  lds
    s_add_u32 m0, s69, 155648
    s_add_u32 s60, s60, s62
    buffer_load_dwordx4 v21, s[48:51], s61 offen  lds
    s_add_u32 s61, s61, 122880
    s_waitcnt vmcnt(8)
    s_barrier
    s_add_u32 m0, s69, 98304
    s_add_u32 s21, s68, 786432
    buffer_load_dwordx4 v20, s[32:35], s21 offen  lds
    s_add_u32 m0, s69, 102400
    s_nop 0
    buffer_load_dwordx4 v20, s[36:39], s21 offen  lds
    s_waitcnt vmcnt(5)
    s_barrier
    s_add_u32 m0, s69, 110592
    s_add_u32 s21, s68, 884736
    buffer_load_dwordx4 v20, s[32:35], s21 offen  lds
    s_add_u32 m0, s69, 114688
    s_nop 0
    buffer_load_dwordx4 v20, s[36:39], s21 offen  lds
    s_waitcnt vmcnt(4)
    s_barrier
    s_add_u32 m0, s69, 122880
    s_add_u32 s21, s68, 983040
    buffer_load_dwordx4 v20, s[32:35], s21 offen  lds
    s_and_b32 s10, s2, 1
    s_lshl_b32 s10, s10, 2
    s_add_u32 s10, s10, s58
    s_lshl_b32 s10, s10, 7
    s_lshr_b32 s11, s2, 1
    s_add_u32 s10, s10, s11
    s_mul_i32 s44, s10, 6554
    s_lshr_b32 s44, s44, 16
    s_mul_i32 s45, s44, 10
    s_add_u32 m0, s69, 126976
    s_nop 0
    buffer_load_dwordx4 v20, s[36:39], s21 offen  lds
    s_sub_u32 s45, s10, s45
    s_sub_u32 s46, s44, 48
    s_mul_i32 s10, s46, 40
    s_mul_i32 s11, s46, 160
    s_sub_u32 s11, s11, 2544
    s_cmp_lt_u32 s44, 64
    s_cselect_b32 s10, s10, s11
    s_cselect_b32 s48, 8, 40
    s_cselect_b32 s49, 20, 80
    s_cselect_b32 s63, 0, 20480
    v_mad_u32_u24 v25, s63, v43, v25
    s_lshl_b32 s11, s44, 5
    s_mov_b32 s42, 819200
    s_waitcnt vmcnt(4)
    s_barrier
    s_add_u32 m0, s69, 135168
    s_add_u32 s21, s68, 1081344
    buffer_load_dwordx4 v20, s[32:35], s21 offen  lds
    s_mov_b32 s43, 0x00020000
    s_cmp_lt_u32 s44, 48
    s_cselect_b32 s10, s11, s10
    s_cselect_b32 s49, 16, s49
    s_cselect_b64 s[40:41], s[64:65], s[66:67]
    s_cselect_b32 s42, 1966080, s42
    s_mul_i32 s10, s10, 1280
    s_lshl_b32 s11, s45, 7
    s_add_u32 s54, s10, s11
    s_mul_i32 s48, s48, 1280
    s_mul_i32 s49, s49, 1280
    s_add_u32 s55, s54, s48
    s_add_u32 s56, s54, s49
    s_add_u32 m0, s69, 139264
    s_nop 0
    buffer_load_dwordx4 v20, s[36:39], s21 offen  lds
    s_add_u32 s57, s55, s49
    v_xor_b32 v21, 32, v25
    s_lshl_b32 s45, s45, 2
    s_add_u32 s10, s45, 0
    s_mul_i32 s11, s10, 205
    s_lshr_b32 s11, s11, 11
    s_mul_i32 s11, s11, 470
    s_add_u32 s11, s11, s10
    s_mul_i32 s63, s44, 10
    s_waitcnt vmcnt(4)
    s_barrier
    s_add_u32 m0, s69, 147456
    s_add_u32 s21, s68, 1179648
    buffer_load_dwordx4 v20, s[32:35], s21 offen  lds
    s_add_u32 s11, s11, s63
    s_mul_i32 s10, s10, 20
    s_add_u32 s10, s10, s46
    s_add_u32 s10, s10, 1920
    s_cmp_lt_u32 s44, 48
    s_cselect_b32 s10, s11, s10
    s_lshl_b32 s10, s10, 10
    s_add_u32 s10, s10, 19398656
    s_cmp_lt_u32 s44, 68
    s_cselect_b32 s48, s10, 1073741824
    s_add_u32 s10, s45, 1
    s_add_u32 m0, s69, 151552
    s_nop 0
    buffer_load_dwordx4 v20, s[36:39], s21 offen  lds
    s_mul_i32 s11, s10, 205
    s_lshr_b32 s11, s11, 11
    s_mul_i32 s11, s11, 470
    s_add_u32 s11, s11, s10
    s_mul_i32 s63, s44, 10
    s_add_u32 s11, s11, s63
    s_mul_i32 s10, s10, 20
    s_add_u32 s10, s10, s46
    s_add_u32 s10, s10, 1920
    s_waitcnt vmcnt(4)
    s_barrier
    s_add_u32 m0, s69, 98304
    s_add_u32 s21, s68, 1277952
    buffer_load_dwordx4 v20, s[32:35], s21 offen  lds
    s_cmp_lt_u32 s44, 48
    s_cselect_b32 s10, s11, s10
    s_lshl_b32 s10, s10, 10
    s_add_u32 s10, s10, 19398656
    s_cmp_lt_u32 s44, 68
    s_cselect_b32 s49, s10, 1073741824
    s_add_u32 s10, s45, 2
    s_mul_i32 s11, s10, 205
    s_lshr_b32 s11, s11, 11
    s_mul_i32 s11, s11, 470
    s_add_u32 s11, s11, s10
    s_add_u32 m0, s69, 102400
    s_nop 0
    buffer_load_dwordx4 v20, s[36:39], s21 offen  lds
    s_mul_i32 s63, s44, 10
    s_add_u32 s11, s11, s63
    s_mul_i32 s10, s10, 20
    s_add_u32 s10, s10, s46
    s_add_u32 s10, s10, 1920
    s_cmp_lt_u32 s44, 48
    s_cselect_b32 s10, s11, s10
    s_lshl_b32 s10, s10, 10
    s_add_u32 s10, s10, 19398656
    s_cmp_lt_u32 s44, 68
    s_cselect_b32 s50, s10, 1073741824
    s_waitcnt vmcnt(4)
    s_barrier
    s_add_u32 m0, s69, 110592
    s_add_u32 s21, s68, 1376256
    buffer_load_dwordx4 v20, s[32:35], s21 offen  lds
    s_add_u32 s10, s45, 3
    s_mul_i32 s11, s10, 205
    s_lshr_b32 s11, s11, 11
    s_mul_i32 s11, s11, 470
    s_add_u32 s11, s11, s10
    s_mul_i32 s63, s44, 10
    s_add_u32 s11, s11, s63
    s_mul_i32 s10, s10, 20
    s_add_u32 s10, s10, s46
    s_add_u32 m0, s69, 114688
    s_nop 0
    buffer_load_dwordx4 v20, s[36:39], s21 offen  lds
    s_add_u32 s10, s10, 1920
    s_cmp_lt_u32 s44, 48
    s_cselect_b32 s10, s11, s10
    s_lshl_b32 s10, s10, 10
    s_add_u32 s10, s10, 19398656
    s_cmp_lt_u32 s44, 68
    s_cselect_b32 s51, s10, 1073741824
    s_mul_i32 s46, s58, 12288
    s_mul_i32 s10, s58, 163840
    s_add_u32 s10, s10, 2621440
    s_lshl_b32 s59, s9, 9
    s_waitcnt vmcnt(4)
    s_barrier
    s_add_u32 m0, s69, 122880
    s_add_u32 s21, s68, 1474560
    buffer_load_dwordx4 v20, s[32:35], s21 offen  lds
    s_add_u32 s59, s59, s10
    s_lshl_b32 s60, s12, 9
    s_add_u32 s60, s60, s10
    s_lshl_b32 s61, s58, 11
    s_add_u32 s61, s61, 7864320
    s_mul_i32 s66, s58, 2560
    s_mul_i32 s65, s58, 3072
    s_lshl_b32 s63, s14, 2
    s_add_u32 s63, s63, s58
    s_mul_i32 s63, s63, 122880
    s_add_u32 m0, s69, 126976
    s_nop 0
    buffer_load_dwordx4 v20, s[36:39], s21 offen  lds
    s_add_u32 s63, s63, 19398656
    s_lshl_b32 s64, s13, 2
    s_add_u32 s64, s64, s58
    s_mul_i32 s64, s64, 24576
    s_add_u32 s64, s64, 10485760
    s_cmp_eq_u32 s58, 3
    s_cselect_b32 s47, 22249476, 1073741824
    ds_read_b32 v8, v10 offset:8
    s_lshl_b32 s67, s58, 13
    s_add_u32 s67, s67, 22183948
    s_waitcnt vmcnt(4)
    s_barrier
    s_setprio 0
    s_add_u32 m0, s69, 135168
    s_add_u32 s21, s68, 1572864
    buffer_load_dwordx4 v20, s[32:35], s21 offen  lds
    s_add_u32 m0, s69, 139264
    s_nop 0
    buffer_load_dwordx4 v20, s[36:39], s21 offen  lds
    s_waitcnt vmcnt(4)
    s_barrier
    s_add_u32 m0, s69, 147456
    s_add_u32 s21, s68, 1671168
    buffer_load_dwordx4 v20, s[32:35], s21 offen  lds
    s_add_u32 m0, s69, 151552
    s_nop 0
    buffer_load_dwordx4 v20, s[36:39], s21 offen  lds
    s_waitcnt vmcnt(4)
    s_barrier
    s_add_u32 m0, s69, 98304
    s_add_u32 s21, s68, 1769472
    buffer_load_dwordx4 v20, s[32:35], s21 offen  lds
    s_add_u32 m0, s69, 102400
    s_nop 0
    buffer_load_dwordx4 v20, s[36:39], s21 offen  lds
    s_waitcnt vmcnt(4)
    s_barrier
    s_add_u32 m0, s5, 65536
    s_add_u32 s20, s4, 0
    buffer_load_dwordx4 v23, s[28:31], s20 offen  lds
    s_add_u32 m0, s5, 66560
    s_add_u32 s20, s4, 10240
    buffer_load_dwordx4 v24, s[28:31], s20 offen  lds
    s_add_u32 m0, s69, 110592
    s_add_u32 s21, s68, 1867776
    buffer_load_dwordx4 v20, s[32:35], s21 offen  lds
    s_add_u32 m0, s69, 114688
    s_nop 0
    buffer_load_dwordx4 v20, s[36:39], s21 offen  lds
    s_waitcnt vmcnt(6)
    s_barrier
    s_add_u32 m0, s5, 67584
    s_add_u32 s20, s4, 20480
    buffer_load_dwordx4 v23, s[28:31], s20 offen  lds
    s_add_u32 m0, s5, 68608
    s_add_u32 s20, s4, 30720
    buffer_load_dwordx4 v24, s[28:31], s20 offen  lds
    s_add_u32 m0, s69, 122880
    s_add_u32 s21, s68, 0
    buffer_load_dwordx4 v20, s[32:35], s21 offen  lds
    s_add_u32 m0, s69, 126976
    s_nop 0
    buffer_load_dwordx4 v20, s[36:39], s21 offen  lds
    s_waitcnt vmcnt(8)
    s_barrier
    s_add_u32 m0, s5, 81920
    s_add_u32 s20, s4, 128
    buffer_load_dwordx4 v23, s[28:31], s20 offen  lds
    s_add_u32 m0, s5, 82944
    s_add_u32 s20, s4, 10368
    buffer_load_dwordx4 v24, s[28:31], s20 offen  lds
    s_add_u32 m0, s69, 135168
    s_add_u32 s21, s68, 98304
    buffer_load_dwordx4 v20, s[32:35], s21 offen  lds
    s_add_u32 m0, s69, 139264
    s_nop 0
    buffer_load_dwordx4 v20, s[36:39], s21 offen  lds
    s_waitcnt vmcnt(8)
    s_barrier
    s_add_u32 m0, s5, 83968
    s_add_u32 s20, s4, 20608
    buffer_load_dwordx4 v23, s[28:31], s20 offen  lds
    s_add_u32 m0, s5, 84992
    s_add_u32 s20, s4, 30848
    buffer_load_dwordx4 v24, s[28:31], s20 offen  lds
    s_add_u32 m0, s69, 147456
    s_add_u32 s21, s68, 196608
    buffer_load_dwordx4 v20, s[32:35], s21 offen  lds
    s_add_u32 m0, s69, 151552
    s_nop 0
    buffer_load_dwordx4 v20, s[36:39], s21 offen  lds
    s_waitcnt vmcnt(8)
    s_barrier
    s_add_u32 m0, s5, 0
    s_add_u32 s20, s4, 256
    buffer_load_dwordx4 v23, s[28:31], s20 offen  lds
    s_add_u32 m0, s5, 1024
    s_add_u32 s20, s4, 10496
    buffer_load_dwordx4 v24, s[28:31], s20 offen  lds
    s_add_u32 m0, s69, 98304
    s_add_u32 s21, s68, 294912
    buffer_load_dwordx4 v20, s[32:35], s21 offen  lds
    s_add_u32 m0, s69, 102400
    s_nop 0
    buffer_load_dwordx4 v20, s[36:39], s21 offen  lds
    s_waitcnt vmcnt(8)
    s_barrier
    s_add_u32 m0, s5, 2048
    s_add_u32 s20, s4, 20736
    buffer_load_dwordx4 v23, s[28:31], s20 offen  lds
    s_add_u32 m0, s5, 3072
    s_add_u32 s20, s4, 30976
    buffer_load_dwordx4 v24, s[28:31], s20 offen  lds
    s_add_u32 m0, s69, 110592
    s_add_u32 s21, s68, 393216
    buffer_load_dwordx4 v20, s[32:35], s21 offen  lds
    s_add_u32 m0, s69, 114688
    s_nop 0
    buffer_load_dwordx4 v20, s[36:39], s21 offen  lds
    s_waitcnt vmcnt(8)
    s_barrier
    s_add_u32 m0, s5, 16384
    s_add_u32 s20, s4, 384
    buffer_load_dwordx4 v23, s[28:31], s20 offen  lds
    s_add_u32 m0, s5, 17408
    s_add_u32 s20, s4, 10624
    buffer_load_dwordx4 v24, s[28:31], s20 offen  lds
    s_add_u32 m0, s69, 122880
    s_add_u32 s21, s68, 491520
    buffer_load_dwordx4 v20, s[32:35], s21 offen  lds
    s_add_u32 m0, s69, 126976
    s_nop 0
    buffer_load_dwordx4 v20, s[36:39], s21 offen  lds
    s_waitcnt vmcnt(8)
    s_barrier
    s_add_u32 m0, s5, 18432
    s_add_u32 s20, s4, 20864
    buffer_load_dwordx4 v23, s[28:31], s20 offen  lds
    s_add_u32 m0, s5, 19456
    s_add_u32 s20, s4, 31104
    buffer_load_dwordx4 v24, s[28:31], s20 offen  lds
    s_add_u32 m0, s69, 135168
    s_add_u32 s21, s68, 589824
    buffer_load_dwordx4 v20, s[32:35], s21 offen  lds
    s_add_u32 m0, s69, 139264
    s_nop 0
    buffer_load_dwordx4 v20, s[36:39], s21 offen  lds
    s_waitcnt vmcnt(8)
    s_barrier
    s_add_u32 m0, s69, 147456
    s_add_u32 s21, s68, 688128
    buffer_load_dwordx4 v20, s[32:35], s21 offen  lds
    s_add_u32 m0, s69, 151552
    s_nop 0
    buffer_load_dwordx4 v20, s[36:39], s21 offen  lds
    s_waitcnt vmcnt(6)
    s_barrier
    s_waitcnt vmcnt(2)
    s_barrier
    buffer_load_dword v9, v6, s[24:27], s47 offen sc1
    buffer_load_dword v5, v12, s[24:27], s47 offen sc1
    s_waitcnt vmcnt(2)
    s_barrier
    s_barrier
    s_waitcnt vmcnt(0)
    s_setprio 3
    s_waitcnt lgkmcnt(0)
    s_cmp_eq_u32 s58, 3
    s_cbranch_scc1 L2_s1a
    s_mov_b32 s10, 2097152
L2_s1w:
    ds_read_b32 v9, v10 offset:0
    s_sub_u32 s10, s10, 1
    s_waitcnt lgkmcnt(0)
    v_cmp_gt_u32 vcc, 1, v9
    s_cbranch_scc1 L2_s1w_x
    s_cbranch_vccnz L2_s1w
L2_s1w_x:
    s_branch L2_s1b
L2_s1a:
    s_mov_b32 s10, 262144
    s_branch L2_s1c
L2_s1p:
    buffer_load_dword v9, v6, s[24:27], s47 offen sc1
    buffer_load_dword v5, v12, s[24:27], s47 offen sc1
    s_waitcnt vmcnt(0)
L2_s1c:
    v_xor_b32 v9, v9, v8
    v_xor_b32 v5, v5, v8
    v_or_b32 v9, v9, v5
    s_sub_u32 s10, s10, 1
    v_cmp_ne_u32 vcc, 0, v9
    s_cbranch_scc1 L2_s1p_x
    s_cbranch_vccnz L2_s1p
L2_s1p_x:
    s_mov_b64 exec, 1
    ds_write_b32 v10, v8 offset:0
    s_mov_b64 exec, -1
L2_s1b:
    v_mov_b32 v12, v16
    s_setprio 0
    s_mul_i32 s10, s7, 655360
    s_add_u32 s59, s59, s10
    s_add_u32 s60, s60, s10
    s_add_u32 m0, s65, 45056
    s_add_u32 s62, s59, 0
    buffer_load_dwordx4 v2, s[24:27], s62 offen sc1 lds
    s_add_u32 s62, s59, 80896
    buffer_load_dwordx4 v2, s[24:27], s62 offen offset:1024 sc1 lds
    s_add_u32 s62, s60, -2048
    buffer_load_dwordx4 v3, s[24:27], s62 offen offset:2048 sc1 lds
    s_sub_u32 s59, s59, s10
    s_sub_u32 s60, s60, s10
    s_add_u32 m0, s65, 0
    s_add_u32 s62, s59, 40960
    buffer_load_dwordx4 v2, s[24:27], s62 offen sc1 lds
    s_add_u32 s62, s59, 121856
    buffer_load_dwordx4 v2, s[24:27], s62 offen offset:1024 sc1 lds
    s_add_u32 s62, s60, 38912
    buffer_load_dwordx4 v3, s[24:27], s62 offen offset:2048 sc1 lds
    s_add_u32 m0, s66, 12288
    s_add_u32 s62, s61, 0
    buffer_load_dwordx4 v13, s[24:27], s62 offen sc1 lds
    s_add_u32 s62, s61, -1024
    buffer_load_dwordx4 v14, s[24:27], s62 offen offset:1024 sc1 lds
    s_add_u32 s62, s61, -2048
    s_mov_b32 exec_hi, 0
    buffer_load_dwordx4 v15, s[24:27], s62 offen offset:2048 sc1 lds
    s_mov_b32 exec_hi, -1
    s_waitcnt vmcnt(0)
    s_barrier
    s_add_u32 m0, s46, 106496
    s_nop 0
    buffer_load_dwordx4 v25, s[40:43], s54 offen lds
    s_add_u32 m0, s46, 107520
    s_nop 0
    buffer_load_dwordx4 v21, s[40:43], s55 offen lds
    s_add_u32 m0, s46, 108544
    s_nop 0
    buffer_load_dwordx4 v25, s[40:43], s56 offen lds
    s_add_u32 m0, s46, 109568
    s_nop 0
    buffer_load_dwordx4 v21, s[40:43], s57 offen lds
    s_add_u32 m0, s65, 22528
    s_add_u32 s62, s59, 696320
    buffer_load_dwordx4 v2, s[24:27], s62 offen sc1 lds
    s_add_u32 s62, s59, 777216
    buffer_load_dwordx4 v2, s[24:27], s62 offen offset:1024 sc1 lds
    s_add_u32 s62, s60, 694272
    buffer_load_dwordx4 v3, s[24:27], s62 offen offset:2048 sc1 lds
    s_add_u32 m0, s66, 34816
    s_add_u32 s62, s61, 8192
    buffer_load_dwordx4 v13, s[24:27], s62 offen sc1 lds
    s_add_u32 s62, s61, 7168
    buffer_load_dwordx4 v14, s[24:27], s62 offen offset:1024 sc1 lds
    s_add_u32 s62, s61, 6144
    s_mov_b32 exec_hi, 0
    buffer_load_dwordx4 v15, s[24:27], s62 offen offset:2048 sc1 lds
    s_mov_b32 exec_hi, -1
    s_waitcnt vmcnt(6)
    ds_read_b64_tr_b16 v[28:29], v26 offset:0
    ds_read_b64_tr_b16 v[30:31], v26 offset:512
    ds_read_b64_tr_b16 v[32:33], v27 offset:0
    ds_read_b64_tr_b16 v[34:35], v27 offset:512
    ds_read_b64_tr_b16 v[36:37], v26 offset:256
    ds_read_b64_tr_b16 v[38:39], v26 offset:768
    ds_read_b64_tr_b16 v[40:41], v27 offset:256
    ds_read_b64_tr_b16 v[42:43], v27 offset:768
    s_waitcnt lgkmcnt(0)
    buffer_store_dwordx4 v[28:31], v2, s[24:27], s48 offen sc1
    buffer_store_dwordx4 v[32:35], v2, s[24:27], s49 offen sc1
    buffer_store_dwordx4 v[36:39], v2, s[24:27], s50 offen sc1
    buffer_store_dwordx4 v[40:43], v2, s[24:27], s51 offen sc1
    s_waitcnt vmcnt(4)
    s_barrier
    s_setprio 3
    s_waitcnt vmcnt(0)
    s_mov_b64 exec, 1
    v_mov_b32 v9, 1
    ds_add_rtn_u32 v9, v10, v9 offset:16
    s_waitcnt lgkmcnt(0)
    v_cmp_eq_u32 vcc, 3, v9
    s_cbranch_vccz L2_h1
    buffer_store_dword v8, v11, s[24:27], 0 offen offset:12 sc1
L2_h1:
    s_mov_b64 exec, -1
    s_add_u32 m0, s65, 45056
    s_add_u32 s62, s59, 1351680
    buffer_load_dwordx4 v2, s[24:27], s62 offen sc1 lds
    s_add_u32 s62, s59, 1432576
    buffer_load_dwordx4 v2, s[24:27], s62 offen offset:1024 sc1 lds
    s_add_u32 s62, s60, 1349632
    buffer_load_dwordx4 v3, s[24:27], s62 offen offset:2048 sc1 lds
    s_add_u32 m0, s66, 57344
    s_add_u32 s62, s61, 16384
    buffer_load_dwordx4 v13, s[24:27], s62 offen sc1 lds
    s_add_u32 s62, s61, 15360
    buffer_load_dwordx4 v14, s[24:27], s62 offen offset:1024 sc1 lds
    s_add_u32 s62, s61, 14336
    s_mov_b32 exec_hi, 0
    buffer_load_dwordx4 v15, s[24:27], s62 offen offset:2048 sc1 lds
    s_mov_b32 exec_hi, -1
    s_waitcnt vmcnt(0)
    s_barrier
    buffer_load_dword v9, v7, s[24:27], s67 offen sc1
    s_add_u32 m0, s65, 0
    s_add_u32 s62, s59, 2007040
    buffer_load_dwordx4 v2, s[24:27], s62 offen sc1 lds
    s_add_u32 s62, s59, 2087936
    buffer_load_dwordx4 v2, s[24:27], s62 offen offset:1024 sc1 lds
    s_add_u32 s62, s60, 2004992
    buffer_load_dwordx4 v3, s[24:27], s62 offen offset:2048 sc1 lds
    s_add_u32 m0, s66, 12288
    s_add_u32 s62, s61, 24576
    buffer_load_dwordx4 v13, s[24:27], s62 offen sc1 lds
    s_add_u32 s62, s61, 23552
    buffer_load_dwordx4 v14, s[24:27], s62 offen offset:1024 sc1 lds
    s_add_u32 s62, s61, 22528
    s_mov_b32 exec_hi, 0
    buffer_load_dwordx4 v15, s[24:27], s62 offen offset:2048 sc1 lds
    s_mov_b32 exec_hi, -1
    s_waitcnt vmcnt(6)
    v_cmp_ne_u32 vcc, v8, v9
    s_cbranch_vccz L2_s2p_x
    s_mov_b32 s10, 262144
L2_s2p:
    buffer_load_dword v9, v7, s[24:27], s67 offen sc1
    s_sub_u32 s10, s10, 1
    s_waitcnt vmcnt(0)
    v_cmp_ne_u32 vcc, v8, v9
    s_cbranch_scc1 L2_s2p_x
    s_cbranch_vccnz L2_s2p
L2_s2p_x:
    s_mov_b64 exec, 1
    v_mov_b32 v9, 1
    ds_add_u32 v10, v9 offset:4
    s_mov_b64 exec, -1
    s_mov_b32 s10, 2097152
L2_s2w:
    ds_read_b32 v9, v10 offset:4
    s_sub_u32 s10, s10, 1
    s_waitcnt lgkmcnt(0)
    v_cmp_gt_u32 vcc, 4, v9
    s_cbranch_scc1 L2_s2w_x
    s_cbranch_vccnz L2_s2w
L2_s2w_x:
    s_mov_b64 exec, -1
    s_setprio 1
    buffer_load_dwordx4 v[96:99], v2, s[24:27], s63 offen offset:0 sc1
    buffer_load_dwordx4 v[100:103], v2, s[24:27], s63 offen offset:1024 sc1
    buffer_load_dwordx4 v[104:107], v2, s[24:27], s63 offen offset:2048 sc1
    buffer_load_dwordx4 v[108:111], v2, s[24:27], s63 offen offset:3072 sc1
    s_add_u32 s63, s63, 4096
    buffer_load_dwordx4 v[112:115], v2, s[24:27], s63 offen sc1
    s_add_u32 s63, s63, 1024
    buffer_load_dwordx4 v[156:159], v12, s[24:27], s64 offen offset:0 sc1
    buffer_load_dwordx4 v[160:163], v12, s[24:27], s64 offen offset:256 sc1
    s_add_u32 s64, s64, 2048
    buffer_load_dwordx4 v[116:119], v2, s[24:27], s63 offen offset:0 sc1
    buffer_load_dwordx4 v[120:123], v2, s[24:27], s63 offen offset:1024 sc1
    buffer_load_dwordx4 v[124:127], v2, s[24:27], s63 offen offset:2048 sc1
    buffer_load_dwordx4 v[128:131], v2, s[24:27], s63 offen offset:3072 sc1
    s_add_u32 s63, s63, 4096
    buffer_load_dwordx4 v[132:135], v2, s[24:27], s63 offen sc1
    s_add_u32 s63, s63, 1024
    buffer_load_dwordx4 v[136:139], v2, s[24:27], s63 offen offset:0 sc1
    buffer_load_dwordx4 v[140:143], v2, s[24:27], s63 offen offset:1024 sc1
    buffer_load_dwordx4 v[144:147], v2, s[24:27], s63 offen offset:2048 sc1
    buffer_load_dwordx4 v[148:151], v2, s[24:27], s63 offen offset:3072 sc1
    s_add_u32 s63, s63, 4096
    buffer_load_dwordx4 v[152:155], v2, s[24:27], s63 offen sc1
    s_add_u32 s63, s63, 1024
    buffer_load_dwordx4 v[164:167], v12, s[24:27], s64 offen offset:0 sc1
    buffer_load_dwordx4 v[4:7], v12, s[24:27], s64 offen offset:256 sc1
    s_add_u32 s64, s64, 2048
    s_waitcnt vmcnt(12)
    v_mfma_f32_16x16x32_bf16 v[16:19], v[96:99], v[156:159], 0
    v_mfma_f32_16x16x32_bf16 v[20:23], v[96:99], v[160:163], 0
    buffer_load_dwordx4 v[96:99], v2, s[24:27], s63 offen offset:0 sc1
    v_mfma_f32_16x16x32_bf16 v[24:27], v[100:103], v[156:159], 0
    v_mfma_f32_16x16x32_bf16 v[28:31], v[100:103], v[160:163], 0
    buffer_load_dwordx4 v[100:103], v2, s[24:27], s63 offen offset:1024 sc1
    v_mfma_f32_16x16x32_bf16 v[32:35], v[104:107], v[156:159], 0
    v_mfma_f32_16x16x32_bf16 v[36:39], v[104:107], v[160:163], 0
    buffer_load_dwordx4 v[104:107], v2, s[24:27], s63 offen offset:2048 sc1
    v_mfma_f32_16x16x32_bf16 v[40:43], v[108:111], v[156:159], 0
    v_mfma_f32_16x16x32_bf16 v[44:47], v[108:111], v[160:163], 0
    buffer_load_dwordx4 v[108:111], v2, s[24:27], s63 offen offset:3072 sc1
    v_mfma_f32_16x16x32_bf16 v[48:51], v[112:115], v[156:159], 0
    v_mfma_f32_16x16x32_bf16 v[52:55], v[112:115], v[160:163], 0
    s_add_u32 s63, s63, 4096
    buffer_load_dwordx4 v[112:115], v2, s[24:27], s63 offen sc1
    s_add_u32 s63, s63, 1024
    s_waitcnt vmcnt(12)
    v_mfma_f32_16x16x32_bf16 v[56:59], v[116:119], v[156:159], 0
    v_mfma_f32_16x16x32_bf16 v[60:63], v[116:119], v[160:163], 0
    buffer_load_dwordx4 v[116:119], v2, s[24:27], s63 offen offset:0 sc1
    v_mfma_f32_16x16x32_bf16 v[64:67], v[120:123], v[156:159], 0
    v_mfma_f32_16x16x32_bf16 v[68:71], v[120:123], v[160:163], 0
    buffer_load_dwordx4 v[120:123], v2, s[24:27], s63 offen offset:1024 sc1
    v_mfma_f32_16x16x32_bf16 v[72:75], v[124:127], v[156:159], 0
    v_mfma_f32_16x16x32_bf16 v[76:79], v[124:127], v[160:163], 0
    buffer_load_dwordx4 v[124:127], v2, s[24:27], s63 offen offset:2048 sc1
    v_mfma_f32_16x16x32_bf16 v[80:83], v[128:131], v[156:159], 0
    v_mfma_f32_16x16x32_bf16 v[84:87], v[128:131], v[160:163], 0
    buffer_load_dwordx4 v[128:131], v2, s[24:27], s63 offen offset:3072 sc1
    v_mfma_f32_16x16x32_bf16 v[88:91], v[132:135], v[156:159], 0
    v_mfma_f32_16x16x32_bf16 v[92:95], v[132:135], v[160:163], 0
    s_add_u32 s63, s63, 4096
    buffer_load_dwordx4 v[132:135], v2, s[24:27], s63 offen sc1
    s_add_u32 s63, s63, 1024
    buffer_load_dwordx4 v[156:159], v12, s[24:27], s64 offen offset:0 sc1
    buffer_load_dwordx4 v[160:163], v12, s[24:27], s64 offen offset:256 sc1
    s_add_u32 s64, s64, 2048
    s_barrier
    s_add_u32 m0, s65, 22528
    s_add_u32 s62, s59, 2662400
    buffer_load_dwordx4 v2, s[24:27], s62 offen sc1 lds
    s_add_u32 s62, s59, 2743296
    buffer_load_dwordx4 v2, s[24:27], s62 offen offset:1024 sc1 lds
    s_add_u32 s62, s60, 2660352
    buffer_load_dwordx4 v3, s[24:27], s62 offen offset:2048 sc1 lds
    s_add_u32 m0, s66, 34816
    s_add_u32 s62, s61, 32768
    buffer_load_dwordx4 v13, s[24:27], s62 offen sc1 lds
    s_add_u32 s62, s61, 31744
    buffer_load_dwordx4 v14, s[24:27], s62 offen offset:1024 sc1 lds
    s_add_u32 s62, s61, 30720
    s_mov_b32 exec_hi, 0
    buffer_load_dwordx4 v15, s[24:27], s62 offen offset:2048 sc1 lds
    s_mov_b32 exec_hi, -1
    s_waitcnt vmcnt(18)
    v_mfma_f32_16x16x32_bf16 v[16:19], v[136:139], v[164:167], v[16:19]
    v_mfma_f32_16x16x32_bf16 v[20:23], v[136:139], v[4:7], v[20:23]
    buffer_load_dwordx4 v[136:139], v2, s[24:27], s63 offen offset:0 sc1
    v_mfma_f32_16x16x32_bf16 v[24:27], v[140:143], v[164:167], v[24:27]
    v_mfma_f32_16x16x32_bf16 v[28:31], v[140:143], v[4:7], v[28:31]
    buffer_load_dwordx4 v[140:143], v2, s[24:27], s63 offen offset:1024 sc1
    v_mfma_f32_16x16x32_bf16 v[32:35], v[144:147], v[164:167], v[32:35]
    v_mfma_f32_16x16x32_bf16 v[36:39], v[144:147], v[4:7], v[36:39]
    buffer_load_dwordx4 v[144:147], v2, s[24:27], s63 offen offset:2048 sc1
    v_mfma_f32_16x16x32_bf16 v[40:43], v[148:151], v[164:167], v[40:43]
    v_mfma_f32_16x16x32_bf16 v[44:47], v[148:151], v[4:7], v[44:47]
    buffer_load_dwordx4 v[148:151], v2, s[24:27], s63 offen offset:3072 sc1
    v_mfma_f32_16x16x32_bf16 v[48:51], v[152:155], v[164:167], v[48:51]
    v_mfma_f32_16x16x32_bf16 v[52:55], v[152:155], v[4:7], v[52:55]
    s_add_u32 s63, s63, 4096
    buffer_load_dwordx4 v[152:155], v2, s[24:27], s63 offen sc1
    s_add_u32 s63, s63, 1024
    s_waitcnt vmcnt(18)
    v_mfma_f32_16x16x32_bf16 v[56:59], v[96:99], v[164:167], v[56:59]
    v_mfma_f32_16x16x32_bf16 v[60:63], v[96:99], v[4:7], v[60:63]
    buffer_load_dwordx4 v[96:99], v2, s[24:27], s63 offen offset:0 sc1
    v_mfma_f32_16x16x32_bf16 v[64:67], v[100:103], v[164:167], v[64:67]
    v_mfma_f32_16x16x32_bf16 v[68:71], v[100:103], v[4:7], v[68:71]
    buffer_load_dwordx4 v[100:103], v2, s[24:27], s63 offen offset:1024 sc1
    v_mfma_f32_16x16x32_bf16 v[72:75], v[104:107], v[164:167], v[72:75]
    v_mfma_f32_16x16x32_bf16 v[76:79], v[104:107], v[4:7], v[76:79]
    buffer_load_dwordx4 v[104:107], v2, s[24:27], s63 offen offset:2048 sc1
    v_mfma_f32_16x16x32_bf16 v[80:83], v[108:111], v[164:167], v[80:83]
    v_mfma_f32_16x16x32_bf16 v[84:87], v[108:111], v[4:7], v[84:87]
    buffer_load_dwordx4 v[108:111], v2, s[24:27], s63 offen offset:3072 sc1
    v_mfma_f32_16x16x32_bf16 v[88:91], v[112:115], v[164:167], v[88:91]
    v_mfma_f32_16x16x32_bf16 v[92:95], v[112:115], v[4:7], v[92:95]
    s_add_u32 s63, s63, 4096
    buffer_load_dwordx4 v[112:115], v2, s[24:27], s63 offen sc1
    s_add_u32 s63, s63, 1024
    buffer_load_dwordx4 v[164:167], v12, s[24:27], s64 offen offset:0 sc1
    buffer_load_dwordx4 v[4:7], v12, s[24:27], s64 offen offset:256 sc1
    s_add_u32 s64, s64, 2048
    s_waitcnt vmcnt(18)
    v_mfma_f32_16x16x32_bf16 v[16:19], v[116:119], v[156:159], v[16:19]
    v_mfma_f32_16x16x32_bf16 v[20:23], v[116:119], v[160:163], v[20:23]
    buffer_load_dwordx4 v[116:119], v2, s[24:27], s63 offen offset:0 sc1
    v_mfma_f32_16x16x32_bf16 v[24:27], v[120:123], v[156:159], v[24:27]
    v_mfma_f32_16x16x32_bf16 v[28:31], v[120:123], v[160:163], v[28:31]
    buffer_load_dwordx4 v[120:123], v2, s[24:27], s63 offen offset:1024 sc1
    v_mfma_f32_16x16x32_bf16 v[32:35], v[124:127], v[156:159], v[32:35]
    v_mfma_f32_16x16x32_bf16 v[36:39], v[124:127], v[160:163], v[36:39]
    buffer_load_dwordx4 v[124:127], v2, s[24:27], s63 offen offset:2048 sc1
    v_mfma_f32_16x16x32_bf16 v[40:43], v[128:131], v[156:159], v[40:43]
    v_mfma_f32_16x16x32_bf16 v[44:47], v[128:131], v[160:163], v[44:47]
    buffer_load_dwordx4 v[128:131], v2, s[24:27], s63 offen offset:3072 sc1
    v_mfma_f32_16x16x32_bf16 v[48:51], v[132:135], v[156:159], v[48:51]
    v_mfma_f32_16x16x32_bf16 v[52:55], v[132:135], v[160:163], v[52:55]
    s_add_u32 s63, s63, 4096
    buffer_load_dwordx4 v[132:135], v2, s[24:27], s63 offen sc1
    s_add_u32 s63, s63, 1024
    s_waitcnt vmcnt(12)
    v_mfma_f32_16x16x32_bf16 v[56:59], v[136:139], v[156:159], v[56:59]
    v_mfma_f32_16x16x32_bf16 v[60:63], v[136:139], v[160:163], v[60:63]
    buffer_load_dwordx4 v[136:139], v2, s[24:27], s63 offen offset:0 sc1
    v_mfma_f32_16x16x32_bf16 v[64:67], v[140:143], v[156:159], v[64:67]
    v_mfma_f32_16x16x32_bf16 v[68:71], v[140:143], v[160:163], v[68:71]
    buffer_load_dwordx4 v[140:143], v2, s[24:27], s63 offen offset:1024 sc1
    v_mfma_f32_16x16x32_bf16 v[72:75], v[144:147], v[156:159], v[72:75]
    v_mfma_f32_16x16x32_bf16 v[76:79], v[144:147], v[160:163], v[76:79]
    buffer_load_dwordx4 v[144:147], v2, s[24:27], s63 offen offset:2048 sc1
    v_mfma_f32_16x16x32_bf16 v[80:83], v[148:151], v[156:159], v[80:83]
    v_mfma_f32_16x16x32_bf16 v[84:87], v[148:151], v[160:163], v[84:87]
    buffer_load_dwordx4 v[148:151], v2, s[24:27], s63 offen offset:3072 sc1
    v_mfma_f32_16x16x32_bf16 v[88:91], v[152:155], v[156:159], v[88:91]
    v_mfma_f32_16x16x32_bf16 v[92:95], v[152:155], v[160:163], v[92:95]
    s_add_u32 s63, s63, 4096
    buffer_load_dwordx4 v[152:155], v2, s[24:27], s63 offen sc1
    s_add_u32 s63, s63, 1024
    buffer_load_dwordx4 v[156:159], v12, s[24:27], s64 offen offset:0 sc1
    buffer_load_dwordx4 v[160:163], v12, s[24:27], s64 offen offset:256 sc1
    s_add_u32 s64, s64, 2048
    s_waitcnt vmcnt(12)
    v_mfma_f32_16x16x32_bf16 v[16:19], v[96:99], v[164:167], v[16:19]
    v_mfma_f32_16x16x32_bf16 v[20:23], v[96:99], v[4:7], v[20:23]
    buffer_load_dwordx4 v[96:99], v2, s[24:27], s63 offen offset:0 sc1
    v_mfma_f32_16x16x32_bf16 v[24:27], v[100:103], v[164:167], v[24:27]
    v_mfma_f32_16x16x32_bf16 v[28:31], v[100:103], v[4:7], v[28:31]
    buffer_load_dwordx4 v[100:103], v2, s[24:27], s63 offen offset:1024 sc1
    v_mfma_f32_16x16x32_bf16 v[32:35], v[104:107], v[164:167], v[32:35]
    v_mfma_f32_16x16x32_bf16 v[36:39], v[104:107], v[4:7], v[36:39]
    buffer_load_dwordx4 v[104:107], v2, s[24:27], s63 offen offset:2048 sc1
    v_mfma_f32_16x16x32_bf16 v[40:43], v[108:111], v[164:167], v[40:43]
    v_mfma_f32_16x16x32_bf16 v[44:47], v[108:111], v[4:7], v[44:47]
    buffer_load_dwordx4 v[108:111], v2, s[24:27], s63 offen offset:3072 sc1
    v_mfma_f32_16x16x32_bf16 v[48:51], v[112:115], v[164:167], v[48:51]
    v_mfma_f32_16x16x32_bf16 v[52:55], v[112:115], v[4:7], v[52:55]
    s_add_u32 s63, s63, 4096
    buffer_load_dwordx4 v[112:115], v2, s[24:27], s63 offen sc1
    s_add_u32 s63, s63, 1024
    s_waitcnt vmcnt(12)
    v_mfma_f32_16x16x32_bf16 v[56:59], v[116:119], v[164:167], v[56:59]
    v_mfma_f32_16x16x32_bf16 v[60:63], v[116:119], v[4:7], v[60:63]
    buffer_load_dwordx4 v[116:119], v2, s[24:27], s63 offen offset:0 sc1
    v_mfma_f32_16x16x32_bf16 v[64:67], v[120:123], v[164:167], v[64:67]
    v_mfma_f32_16x16x32_bf16 v[68:71], v[120:123], v[4:7], v[68:71]
    buffer_load_dwordx4 v[120:123], v2, s[24:27], s63 offen offset:1024 sc1
    v_mfma_f32_16x16x32_bf16 v[72:75], v[124:127], v[164:167], v[72:75]
    v_mfma_f32_16x16x32_bf16 v[76:79], v[124:127], v[4:7], v[76:79]
    buffer_load_dwordx4 v[124:127], v2, s[24:27], s63 offen offset:2048 sc1
    v_mfma_f32_16x16x32_bf16 v[80:83], v[128:131], v[164:167], v[80:83]
    v_mfma_f32_16x16x32_bf16 v[84:87], v[128:131], v[4:7], v[84:87]
    buffer_load_dwordx4 v[128:131], v2, s[24:27], s63 offen offset:3072 sc1
    v_mfma_f32_16x16x32_bf16 v[88:91], v[132:135], v[164:167], v[88:91]
    v_mfma_f32_16x16x32_bf16 v[92:95], v[132:135], v[4:7], v[92:95]
    s_add_u32 s63, s63, 4096
    buffer_load_dwordx4 v[132:135], v2, s[24:27], s63 offen sc1
    s_add_u32 s63, s63, 1024
    buffer_load_dwordx4 v[164:167], v12, s[24:27], s64 offen offset:0 sc1
    buffer_load_dwordx4 v[4:7], v12, s[24:27], s64 offen offset:256 sc1
    s_add_u32 s64, s64, 2048
    s_barrier
    s_add_u32 m0, s65, 45056
    s_add_u32 s62, s59, 3317760
    buffer_load_dwordx4 v2, s[24:27], s62 offen sc1 lds
    s_add_u32 s62, s59, 3398656
    buffer_load_dwordx4 v2, s[24:27], s62 offen offset:1024 sc1 lds
    s_add_u32 s62, s60, 3315712
    buffer_load_dwordx4 v3, s[24:27], s62 offen offset:2048 sc1 lds
    s_add_u32 m0, s66, 57344
    s_add_u32 s62, s61, 40960
    buffer_load_dwordx4 v13, s[24:27], s62 offen sc1 lds
    s_add_u32 s62, s61, 39936
    buffer_load_dwordx4 v14, s[24:27], s62 offen offset:1024 sc1 lds
    s_add_u32 s62, s61, 38912
    s_mov_b32 exec_hi, 0
    buffer_load_dwordx4 v15, s[24:27], s62 offen offset:2048 sc1 lds
    s_mov_b32 exec_hi, -1
    s_waitcnt vmcnt(18)
    v_mfma_f32_16x16x32_bf16 v[16:19], v[136:139], v[156:159], v[16:19]
    v_mfma_f32_16x16x32_bf16 v[20:23], v[136:139], v[160:163], v[20:23]
    buffer_load_dwordx4 v[136:139], v2, s[24:27], s63 offen offset:0 sc1
    v_mfma_f32_16x16x32_bf16 v[24:27], v[140:143], v[156:159], v[24:27]
    v_mfma_f32_16x16x32_bf16 v[28:31], v[140:143], v[160:163], v[28:31]
    buffer_load_dwordx4 v[140:143], v2, s[24:27], s63 offen offset:1024 sc1
    v_mfma_f32_16x16x32_bf16 v[32:35], v[144:147], v[156:159], v[32:35]
    v_mfma_f32_16x16x32_bf16 v[36:39], v[144:147], v[160:163], v[36:39]
    buffer_load_dwordx4 v[144:147], v2, s[24:27], s63 offen offset:2048 sc1
    v_mfma_f32_16x16x32_bf16 v[40:43], v[148:151], v[156:159], v[40:43]
    v_mfma_f32_16x16x32_bf16 v[44:47], v[148:151], v[160:163], v[44:47]
    buffer_load_dwordx4 v[148:151], v2, s[24:27], s63 offen offset:3072 sc1
    v_mfma_f32_16x16x32_bf16 v[48:51], v[152:155], v[156:159], v[48:51]
    v_mfma_f32_16x16x32_bf16 v[52:55], v[152:155], v[160:163], v[52:55]
    s_add_u32 s63, s63, 4096
    buffer_load_dwordx4 v[152:155], v2, s[24:27], s63 offen sc1
    s_add_u32 s63, s63, 1024
    s_waitcnt vmcnt(18)
    v_mfma_f32_16x16x32_bf16 v[56:59], v[96:99], v[156:159], v[56:59]
    v_mfma_f32_16x16x32_bf16 v[60:63], v[96:99], v[160:163], v[60:63]
    buffer_load_dwordx4 v[96:99], v2, s[24:27], s63 offen offset:0 sc1
    v_mfma_f32_16x16x32_bf16 v[64:67], v[100:103], v[156:159], v[64:67]
    v_mfma_f32_16x16x32_bf16 v[68:71], v[100:103], v[160:163], v[68:71]
    buffer_load_dwordx4 v[100:103], v2, s[24:27], s63 offen offset:1024 sc1
    v_mfma_f32_16x16x32_bf16 v[72:75], v[104:107], v[156:159], v[72:75]
    v_mfma_f32_16x16x32_bf16 v[76:79], v[104:107], v[160:163], v[76:79]
    buffer_load_dwordx4 v[104:107], v2, s[24:27], s63 offen offset:2048 sc1
    v_mfma_f32_16x16x32_bf16 v[80:83], v[108:111], v[156:159], v[80:83]
    v_mfma_f32_16x16x32_bf16 v[84:87], v[108:111], v[160:163], v[84:87]
    buffer_load_dwordx4 v[108:111], v2, s[24:27], s63 offen offset:3072 sc1
    v_mfma_f32_16x16x32_bf16 v[88:91], v[112:115], v[156:159], v[88:91]
    v_mfma_f32_16x16x32_bf16 v[92:95], v[112:115], v[160:163], v[92:95]
    s_add_u32 s63, s63, 4096
    buffer_load_dwordx4 v[112:115], v2, s[24:27], s63 offen sc1
    s_add_u32 s63, s63, 1024
    buffer_load_dwordx4 v[156:159], v12, s[24:27], s64 offen offset:0 sc1
    buffer_load_dwordx4 v[160:163], v12, s[24:27], s64 offen offset:256 sc1
    s_add_u32 s64, s64, 2048
    s_waitcnt vmcnt(18)
    v_mfma_f32_16x16x32_bf16 v[16:19], v[116:119], v[164:167], v[16:19]
    v_mfma_f32_16x16x32_bf16 v[20:23], v[116:119], v[4:7], v[20:23]
    buffer_load_dwordx4 v[116:119], v2, s[24:27], s63 offen offset:0 sc1
    v_mfma_f32_16x16x32_bf16 v[24:27], v[120:123], v[164:167], v[24:27]
    v_mfma_f32_16x16x32_bf16 v[28:31], v[120:123], v[4:7], v[28:31]
    buffer_load_dwordx4 v[120:123], v2, s[24:27], s63 offen offset:1024 sc1
    v_mfma_f32_16x16x32_bf16 v[32:35], v[124:127], v[164:167], v[32:35]
    v_mfma_f32_16x16x32_bf16 v[36:39], v[124:127], v[4:7], v[36:39]
    buffer_load_dwordx4 v[124:127], v2, s[24:27], s63 offen offset:2048 sc1
    v_mfma_f32_16x16x32_bf16 v[40:43], v[128:131], v[164:167], v[40:43]
    v_mfma_f32_16x16x32_bf16 v[44:47], v[128:131], v[4:7], v[44:47]
    buffer_load_dwordx4 v[128:131], v2, s[24:27], s63 offen offset:3072 sc1
    v_mfma_f32_16x16x32_bf16 v[48:51], v[132:135], v[164:167], v[48:51]
    v_mfma_f32_16x16x32_bf16 v[52:55], v[132:135], v[4:7], v[52:55]
    s_add_u32 s63, s63, 4096
    buffer_load_dwordx4 v[132:135], v2, s[24:27], s63 offen sc1
    s_add_u32 s63, s63, 1024
    s_waitcnt vmcnt(12)
    v_mfma_f32_16x16x32_bf16 v[56:59], v[136:139], v[164:167], v[56:59]
    v_mfma_f32_16x16x32_bf16 v[60:63], v[136:139], v[4:7], v[60:63]
    buffer_load_dwordx4 v[136:139], v2, s[24:27], s63 offen offset:0 sc1
    v_mfma_f32_16x16x32_bf16 v[64:67], v[140:143], v[164:167], v[64:67]
    v_mfma_f32_16x16x32_bf16 v[68:71], v[140:143], v[4:7], v[68:71]
    buffer_load_dwordx4 v[140:143], v2, s[24:27], s63 offen offset:1024 sc1
    v_mfma_f32_16x16x32_bf16 v[72:75], v[144:147], v[164:167], v[72:75]
    v_mfma_f32_16x16x32_bf16 v[76:79], v[144:147], v[4:7], v[76:79]
    buffer_load_dwordx4 v[144:147], v2, s[24:27], s63 offen offset:2048 sc1
    v_mfma_f32_16x16x32_bf16 v[80:83], v[148:151], v[164:167], v[80:83]
    v_mfma_f32_16x16x32_bf16 v[84:87], v[148:151], v[4:7], v[84:87]
    buffer_load_dwordx4 v[148:151], v2, s[24:27], s63 offen offset:3072 sc1
    v_mfma_f32_16x16x32_bf16 v[88:91], v[152:155], v[164:167], v[88:91]
    v_mfma_f32_16x16x32_bf16 v[92:95], v[152:155], v[4:7], v[92:95]
    s_add_u32 s63, s63, 4096
    buffer_load_dwordx4 v[152:155], v2, s[24:27], s63 offen sc1
    s_add_u32 s63, s63, 1024
    buffer_load_dwordx4 v[164:167], v12, s[24:27], s64 offen offset:0 sc1
    buffer_load_dwordx4 v[4:7], v12, s[24:27], s64 offen offset:256 sc1
    s_add_u32 s64, s64, 2048
    s_waitcnt vmcnt(12)
    v_mfma_f32_16x16x32_bf16 v[16:19], v[96:99], v[156:159], v[16:19]
    v_mfma_f32_16x16x32_bf16 v[20:23], v[96:99], v[160:163], v[20:23]
    buffer_load_dwordx4 v[96:99], v2, s[24:27], s63 offen offset:0 sc1
    v_mfma_f32_16x16x32_bf16 v[24:27], v[100:103], v[156:159], v[24:27]
    v_mfma_f32_16x16x32_bf16 v[28:31], v[100:103], v[160:163], v[28:31]
    buffer_load_dwordx4 v[100:103], v2, s[24:27], s63 offen offset:1024 sc1
    v_mfma_f32_16x16x32_bf16 v[32:35], v[104:107], v[156:159], v[32:35]
    v_mfma_f32_16x16x32_bf16 v[36:39], v[104:107], v[160:163], v[36:39]
    buffer_load_dwordx4 v[104:107], v2, s[24:27], s63 offen offset:2048 sc1
    v_mfma_f32_16x16x32_bf16 v[40:43], v[108:111], v[156:159], v[40:43]
    v_mfma_f32_16x16x32_bf16 v[44:47], v[108:111], v[160:163], v[44:47]
    buffer_load_dwordx4 v[108:111], v2, s[24:27], s63 offen offset:3072 sc1
    v_mfma_f32_16x16x32_bf16 v[48:51], v[112:115], v[156:159], v[48:51]
    v_mfma_f32_16x16x32_bf16 v[52:55], v[112:115], v[160:163], v[52:55]
    s_add_u32 s63, s63, 4096
    buffer_load_dwordx4 v[112:115], v2, s[24:27], s63 offen sc1
    s_add_u32 s63, s63, 1024
    s_waitcnt vmcnt(12)
    v_mfma_f32_16x16x32_bf16 v[56:59], v[116:119], v[156:159], v[56:59]
    v_mfma_f32_16x16x32_bf16 v[60:63], v[116:119], v[160:163], v[60:63]
    buffer_load_dwordx4 v[116:119], v2, s[24:27], s63 offen offset:0 sc1
    v_mfma_f32_16x16x32_bf16 v[64:67], v[120:123], v[156:159], v[64:67]
    v_mfma_f32_16x16x32_bf16 v[68:71], v[120:123], v[160:163], v[68:71]
    buffer_load_dwordx4 v[120:123], v2, s[24:27], s63 offen offset:1024 sc1
    v_mfma_f32_16x16x32_bf16 v[72:75], v[124:127], v[156:159], v[72:75]
    v_mfma_f32_16x16x32_bf16 v[76:79], v[124:127], v[160:163], v[76:79]
    buffer_load_dwordx4 v[124:127], v2, s[24:27], s63 offen offset:2048 sc1
    v_mfma_f32_16x16x32_bf16 v[80:83], v[128:131], v[156:159], v[80:83]
    v_mfma_f32_16x16x32_bf16 v[84:87], v[128:131], v[160:163], v[84:87]
    buffer_load_dwordx4 v[128:131], v2, s[24:27], s63 offen offset:3072 sc1
    v_mfma_f32_16x16x32_bf16 v[88:91], v[132:135], v[156:159], v[88:91]
    v_mfma_f32_16x16x32_bf16 v[92:95], v[132:135], v[160:163], v[92:95]
    s_add_u32 s63, s63, 4096
    buffer_load_dwordx4 v[132:135], v2, s[24:27], s63 offen sc1
    s_add_u32 s63, s63, 1024
    buffer_load_dwordx4 v[156:159], v12, s[24:27], s64 offen offset:0 sc1
    buffer_load_dwordx4 v[160:163], v12, s[24:27], s64 offen offset:256 sc1
    s_add_u32 s64, s64, 2048
    s_barrier
    s_add_u32 m0, s65, 0
    s_add_u32 s62, s59, 3973120
    buffer_load_dwordx4 v2, s[24:27], s62 offen sc1 lds
    s_add_u32 s62, s59, 4054016
    buffer_load_dwordx4 v2, s[24:27], s62 offen offset:1024 sc1 lds
    s_add_u32 s62, s60, 3971072
    buffer_load_dwordx4 v3, s[24:27], s62 offen offset:2048 sc1 lds
    s_add_u32 m0, s66, 12288
    s_add_u32 s62, s61, 49152
    buffer_load_dwordx4 v13, s[24:27], s62 offen sc1 lds
    s_add_u32 s62, s61, 48128
    buffer_load_dwordx4 v14, s[24:27], s62 offen offset:1024 sc1 lds
    s_add_u32 s62, s61, 47104
    s_mov_b32 exec_hi, 0
    buffer_load_dwordx4 v15, s[24:27], s62 offen offset:2048 sc1 lds
    s_mov_b32 exec_hi, -1
    s_waitcnt vmcnt(18)
    v_mfma_f32_16x16x32_bf16 v[16:19], v[136:139], v[164:167], v[16:19]
    v_mfma_f32_16x16x32_bf16 v[20:23], v[136:139], v[4:7], v[20:23]
    buffer_load_dwordx4 v[136:139], v2, s[24:27], s63 offen offset:0 sc1
    v_mfma_f32_16x16x32_bf16 v[24:27], v[140:143], v[164:167], v[24:27]
    v_mfma_f32_16x16x32_bf16 v[28:31], v[140:143], v[4:7], v[28:31]
    buffer_load_dwordx4 v[140:143], v2, s[24:27], s63 offen offset:1024 sc1
    v_mfma_f32_16x16x32_bf16 v[32:35], v[144:147], v[164:167], v[32:35]
    v_mfma_f32_16x16x32_bf16 v[36:39], v[144:147], v[4:7], v[36:39]
    buffer_load_dwordx4 v[144:147], v2, s[24:27], s63 offen offset:2048 sc1
    v_mfma_f32_16x16x32_bf16 v[40:43], v[148:151], v[164:167], v[40:43]
    v_mfma_f32_16x16x32_bf16 v[44:47], v[148:151], v[4:7], v[44:47]
    buffer_load_dwordx4 v[148:151], v2, s[24:27], s63 offen offset:3072 sc1
    v_mfma_f32_16x16x32_bf16 v[48:51], v[152:155], v[164:167], v[48:51]
    v_mfma_f32_16x16x32_bf16 v[52:55], v[152:155], v[4:7], v[52:55]
    s_add_u32 s63, s63, 4096
    buffer_load_dwordx4 v[152:155], v2, s[24:27], s63 offen sc1
    s_add_u32 s63, s63, 1024
    s_waitcnt vmcnt(18)
    v_mfma_f32_16x16x32_bf16 v[56:59], v[96:99], v[164:167], v[56:59]
    v_mfma_f32_16x16x32_bf16 v[60:63], v[96:99], v[4:7], v[60:63]
    buffer_load_dwordx4 v[96:99], v2, s[24:27], s63 offen offset:0 sc1
    v_mfma_f32_16x16x32_bf16 v[64:67], v[100:103], v[164:167], v[64:67]
    v_mfma_f32_16x16x32_bf16 v[68:71], v[100:103], v[4:7], v[68:71]
    buffer_load_dwordx4 v[100:103], v2, s[24:27], s63 offen offset:1024 sc1
    v_mfma_f32_16x16x32_bf16 v[72:75], v[104:107], v[164:167], v[72:75]
    v_mfma_f32_16x16x32_bf16 v[76:79], v[104:107], v[4:7], v[76:79]
    buffer_load_dwordx4 v[104:107], v2, s[24:27], s63 offen offset:2048 sc1
    v_mfma_f32_16x16x32_bf16 v[80:83], v[108:111], v[164:167], v[80:83]
    v_mfma_f32_16x16x32_bf16 v[84:87], v[108:111], v[4:7], v[84:87]
    buffer_load_dwordx4 v[108:111], v2, s[24:27], s63 offen offset:3072 sc1
    v_mfma_f32_16x16x32_bf16 v[88:91], v[112:115], v[164:167], v[88:91]
    v_mfma_f32_16x16x32_bf16 v[92:95], v[112:115], v[4:7], v[92:95]
    s_add_u32 s63, s63, 4096
    buffer_load_dwordx4 v[112:115], v2, s[24:27], s63 offen sc1
    s_add_u32 s63, s63, 1024
    buffer_load_dwordx4 v[164:167], v12, s[24:27], s64 offen offset:0 sc1
    buffer_load_dwordx4 v[4:7], v12, s[24:27], s64 offen offset:256 sc1
    s_add_u32 s64, s64, 2048
    s_waitcnt vmcnt(18)
    v_mfma_f32_16x16x32_bf16 v[16:19], v[116:119], v[156:159], v[16:19]
    v_mfma_f32_16x16x32_bf16 v[20:23], v[116:119], v[160:163], v[20:23]
    buffer_load_dwordx4 v[116:119], v2, s[24:27], s63 offen offset:0 sc1
    v_mfma_f32_16x16x32_bf16 v[24:27], v[120:123], v[156:159], v[24:27]
    v_mfma_f32_16x16x32_bf16 v[28:31], v[120:123], v[160:163], v[28:31]
    buffer_load_dwordx4 v[120:123], v2, s[24:27], s63 offen offset:1024 sc1
    v_mfma_f32_16x16x32_bf16 v[32:35], v[124:127], v[156:159], v[32:35]
    v_mfma_f32_16x16x32_bf16 v[36:39], v[124:127], v[160:163], v[36:39]
    buffer_load_dwordx4 v[124:127], v2, s[24:27], s63 offen offset:2048 sc1
    v_mfma_f32_16x16x32_bf16 v[40:43], v[128:131], v[156:159], v[40:43]
    v_mfma_f32_16x16x32_bf16 v[44:47], v[128:131], v[160:163], v[44:47]
    buffer_load_dwordx4 v[128:131], v2, s[24:27], s63 offen offset:3072 sc1
    v_mfma_f32_16x16x32_bf16 v[48:51], v[132:135], v[156:159], v[48:51]
    v_mfma_f32_16x16x32_bf16 v[52:55], v[132:135], v[160:163], v[52:55]
    s_add_u32 s63, s63, 4096
    buffer_load_dwordx4 v[132:135], v2, s[24:27], s63 offen sc1
    s_add_u32 s63, s63, 1024
    s_waitcnt vmcnt(12)
    v_mfma_f32_16x16x32_bf16 v[56:59], v[136:139], v[156:159], v[56:59]
    v_mfma_f32_16x16x32_bf16 v[60:63], v[136:139], v[160:163], v[60:63]
    buffer_load_dwordx4 v[136:139], v2, s[24:27], s63 offen offset:0 sc1
    v_mfma_f32_16x16x32_bf16 v[64:67], v[140:143], v[156:159], v[64:67]
    v_mfma_f32_16x16x32_bf16 v[68:71], v[140:143], v[160:163], v[68:71]
    buffer_load_dwordx4 v[140:143], v2, s[24:27], s63 offen offset:1024 sc1
    v_mfma_f32_16x16x32_bf16 v[72:75], v[144:147], v[156:159], v[72:75]
    v_mfma_f32_16x16x32_bf16 v[76:79], v[144:147], v[160:163], v[76:79]
    buffer_load_dwordx4 v[144:147], v2, s[24:27], s63 offen offset:2048 sc1
    v_mfma_f32_16x16x32_bf16 v[80:83], v[148:151], v[156:159], v[80:83]
    v_mfma_f32_16x16x32_bf16 v[84:87], v[148:151], v[160:163], v[84:87]
    buffer_load_dwordx4 v[148:151], v2, s[24:27], s63 offen offset:3072 sc1
    v_mfma_f32_16x16x32_bf16 v[88:91], v[152:155], v[156:159], v[88:91]
    v_mfma_f32_16x16x32_bf16 v[92:95], v[152:155], v[160:163], v[92:95]
    s_add_u32 s63, s63, 4096
    buffer_load_dwordx4 v[152:155], v2, s[24:27], s63 offen sc1
    s_add_u32 s63, s63, 1024
    buffer_load_dwordx4 v[156:159], v12, s[24:27], s64 offen offset:0 sc1
    buffer_load_dwordx4 v[160:163], v12, s[24:27], s64 offen offset:256 sc1
    s_add_u32 s64, s64, 2048
    s_waitcnt vmcnt(12)
    v_mfma_f32_16x16x32_bf16 v[16:19], v[96:99], v[164:167], v[16:19]
    v_mfma_f32_16x16x32_bf16 v[20:23], v[96:99], v[4:7], v[20:23]
    buffer_load_dwordx4 v[96:99], v2, s[24:27], s63 offen offset:0 sc1
    v_mfma_f32_16x16x32_bf16 v[24:27], v[100:103], v[164:167], v[24:27]
    v_mfma_f32_16x16x32_bf16 v[28:31], v[100:103], v[4:7], v[28:31]
    buffer_load_dwordx4 v[100:103], v2, s[24:27], s63 offen offset:1024 sc1
    v_mfma_f32_16x16x32_bf16 v[32:35], v[104:107], v[164:167], v[32:35]
    v_mfma_f32_16x16x32_bf16 v[36:39], v[104:107], v[4:7], v[36:39]
    buffer_load_dwordx4 v[104:107], v2, s[24:27], s63 offen offset:2048 sc1
    v_mfma_f32_16x16x32_bf16 v[40:43], v[108:111], v[164:167], v[40:43]
    v_mfma_f32_16x16x32_bf16 v[44:47], v[108:111], v[4:7], v[44:47]
    buffer_load_dwordx4 v[108:111], v2, s[24:27], s63 offen offset:3072 sc1
    v_mfma_f32_16x16x32_bf16 v[48:51], v[112:115], v[164:167], v[48:51]
    v_mfma_f32_16x16x32_bf16 v[52:55], v[112:115], v[4:7], v[52:55]
    s_add_u32 s63, s63, 4096
    buffer_load_dwordx4 v[112:115], v2, s[24:27], s63 offen sc1
    s_add_u32 s63, s63, 1024
    s_barrier
    s_add_u32 m0, s65, 22528
    s_add_u32 s62, s59, 4628480
    buffer_load_dwordx4 v2, s[24:27], s62 offen sc1 lds
    s_add_u32 s62, s59, 4709376
    buffer_load_dwordx4 v2, s[24:27], s62 offen offset:1024 sc1 lds
    s_add_u32 s62, s60, 4626432
    buffer_load_dwordx4 v3, s[24:27], s62 offen offset:2048 sc1 lds
    s_add_u32 m0, s66, 34816
    s_add_u32 s62, s61, 57344
    buffer_load_dwordx4 v13, s[24:27], s62 offen sc1 lds
    s_add_u32 s62, s61, 56320
    buffer_load_dwordx4 v14, s[24:27], s62 offen offset:1024 sc1 lds
    s_add_u32 s62, s61, 55296
    s_mov_b32 exec_hi, 0
    buffer_load_dwordx4 v15, s[24:27], s62 offen offset:2048 sc1 lds
    s_mov_b32 exec_hi, -1
    s_waitcnt vmcnt(18)
    v_mfma_f32_16x16x32_bf16 v[56:59], v[116:119], v[164:167], v[56:59]
    v_mfma_f32_16x16x32_bf16 v[60:63], v[116:119], v[4:7], v[60:63]
    buffer_load_dwordx4 v[116:119], v2, s[24:27], s63 offen offset:0 sc1
    v_mfma_f32_16x16x32_bf16 v[64:67], v[120:123], v[164:167], v[64:67]
    v_mfma_f32_16x16x32_bf16 v[68:71], v[120:123], v[4:7], v[68:71]
    buffer_load_dwordx4 v[120:123], v2, s[24:27], s63 offen offset:1024 sc1
    v_mfma_f32_16x16x32_bf16 v[72:75], v[124:127], v[164:167], v[72:75]
    v_mfma_f32_16x16x32_bf16 v[76:79], v[124:127], v[4:7], v[76:79]
    buffer_load_dwordx4 v[124:127], v2, s[24:27], s63 offen offset:2048 sc1
    v_mfma_f32_16x16x32_bf16 v[80:83], v[128:131], v[164:167], v[80:83]
    v_mfma_f32_16x16x32_bf16 v[84:87], v[128:131], v[4:7], v[84:87]
    buffer_load_dwordx4 v[128:131], v2, s[24:27], s63 offen offset:3072 sc1
    v_mfma_f32_16x16x32_bf16 v[88:91], v[132:135], v[164:167], v[88:91]
    v_mfma_f32_16x16x32_bf16 v[92:95], v[132:135], v[4:7], v[92:95]
    s_add_u32 s63, s63, 4096
    buffer_load_dwordx4 v[132:135], v2, s[24:27], s63 offen sc1
    s_add_u32 s63, s63, 1024
    buffer_load_dwordx4 v[164:167], v12, s[24:27], s64 offen offset:0 sc1
    buffer_load_dwordx4 v[4:7], v12, s[24:27], s64 offen offset:256 sc1
    s_add_u32 s64, s64, 2048
    s_waitcnt vmcnt(18)
    v_mfma_f32_16x16x32_bf16 v[16:19], v[136:139], v[156:159], v[16:19]
    v_mfma_f32_16x16x32_bf16 v[20:23], v[136:139], v[160:163], v[20:23]
    buffer_load_dwordx4 v[136:139], v2, s[24:27], s63 offen offset:0 sc1
    v_mfma_f32_16x16x32_bf16 v[24:27], v[140:143], v[156:159], v[24:27]
    v_mfma_f32_16x16x32_bf16 v[28:31], v[140:143], v[160:163], v[28:31]
    buffer_load_dwordx4 v[140:143], v2, s[24:27], s63 offen offset:1024 sc1
    v_mfma_f32_16x16x32_bf16 v[32:35], v[144:147], v[156:159], v[32:35]
    v_mfma_f32_16x16x32_bf16 v[36:39], v[144:147], v[160:163], v[36:39]
    buffer_load_dwordx4 v[144:147], v2, s[24:27], s63 offen offset:2048 sc1
    v_mfma_f32_16x16x32_bf16 v[40:43], v[148:151], v[156:159], v[40:43]
    v_mfma_f32_16x16x32_bf16 v[44:47], v[148:151], v[160:163], v[44:47]
    buffer_load_dwordx4 v[148:151], v2, s[24:27], s63 offen offset:3072 sc1
    v_mfma_f32_16x16x32_bf16 v[48:51], v[152:155], v[156:159], v[48:51]
    v_mfma_f32_16x16x32_bf16 v[52:55], v[152:155], v[160:163], v[52:55]
    s_add_u32 s63, s63, 4096
    buffer_load_dwordx4 v[152:155], v2, s[24:27], s63 offen sc1
    s_add_u32 s63, s63, 1024
    s_waitcnt vmcnt(18)
    v_mfma_f32_16x16x32_bf16 v[56:59], v[96:99], v[156:159], v[56:59]
    v_mfma_f32_16x16x32_bf16 v[60:63], v[96:99], v[160:163], v[60:63]
    v_mfma_f32_16x16x32_bf16 v[64:67], v[100:103], v[156:159], v[64:67]
    v_mfma_f32_16x16x32_bf16 v[68:71], v[100:103], v[160:163], v[68:71]
    v_mfma_f32_16x16x32_bf16 v[72:75], v[104:107], v[156:159], v[72:75]
    v_mfma_f32_16x16x32_bf16 v[76:79], v[104:107], v[160:163], v[76:79]
    v_mfma_f32_16x16x32_bf16 v[80:83], v[108:111], v[156:159], v[80:83]
    v_mfma_f32_16x16x32_bf16 v[84:87], v[108:111], v[160:163], v[84:87]
    v_mfma_f32_16x16x32_bf16 v[88:91], v[112:115], v[156:159], v[88:91]
    v_mfma_f32_16x16x32_bf16 v[92:95], v[112:115], v[160:163], v[92:95]
    s_waitcnt vmcnt(5)
    v_mfma_f32_16x16x32_bf16 v[16:19], v[116:119], v[164:167], v[16:19]
    v_mfma_f32_16x16x32_bf16 v[20:23], v[116:119], v[4:7], v[20:23]
    v_mfma_f32_16x16x32_bf16 v[24:27], v[120:123], v[164:167], v[24:27]
    v_mfma_f32_16x16x32_bf16 v[28:31], v[120:123], v[4:7], v[28:31]
    v_mfma_f32_16x16x32_bf16 v[32:35], v[124:127], v[164:167], v[32:35]
    v_mfma_f32_16x16x32_bf16 v[36:39], v[124:127], v[4:7], v[36:39]
    v_mfma_f32_16x16x32_bf16 v[40:43], v[128:131], v[164:167], v[40:43]
    v_mfma_f32_16x16x32_bf16 v[44:47], v[128:131], v[4:7], v[44:47]
    v_mfma_f32_16x16x32_bf16 v[48:51], v[132:135], v[164:167], v[48:51]
    v_mfma_f32_16x16x32_bf16 v[52:55], v[132:135], v[4:7], v[52:55]
    s_waitcnt vmcnt(0)
    v_mfma_f32_16x16x32_bf16 v[56:59], v[136:139], v[164:167], v[56:59]
    v_mfma_f32_16x16x32_bf16 v[60:63], v[136:139], v[4:7], v[60:63]
    v_mfma_f32_16x16x32_bf16 v[64:67], v[140:143], v[164:167], v[64:67]
    v_mfma_f32_16x16x32_bf16 v[68:71], v[140:143], v[4:7], v[68:71]
    v_mfma_f32_16x16x32_bf16 v[72:75], v[144:147], v[164:167], v[72:75]
    v_mfma_f32_16x16x32_bf16 v[76:79], v[144:147], v[4:7], v[76:79]
    v_mfma_f32_16x16x32_bf16 v[80:83], v[148:151], v[164:167], v[80:83]
    v_mfma_f32_16x16x32_bf16 v[84:87], v[148:151], v[4:7], v[84:87]
    v_mfma_f32_16x16x32_bf16 v[88:91], v[152:155], v[164:167], v[88:91]
    v_mfma_f32_16x16x32_bf16 v[92:95], v[152:155], v[4:7], v[92:95]
    s_cmp_lg_u32 s58, 0
    s_cbranch_scc1 L_nort
    s_setprio 3
    s_getpc_b64 s[20:21]
L_pc2:
    v_lshrrev_b32 v5, 5, v0
    v_mul_u32_u24 v5, L2_out-L_pc2-4096, v5
    v_lshl_add_u32 v5, v0, 7, v5
    v_min_u32 v5, L_codeend-L_pc2-4, v5
    v_mov_b32 v7, s21
    v_add_co_u32 v6, vcc, s20, v5
    s_nop 1
    v_addc_co_u32 v7, vcc, 0, v7, vcc
    s_mov_b32 exec_lo, 0xfffff
    s_mov_b32 exec_hi, 0xffff
    global_load_dword v100, v[6:7], off
    s_mov_b64 exec, -1
    s_setprio 1
L_nort:
    s_barrier
    s_and_b32 s20, s58, 1
    s_lshl_b32 s10, s20, 10
    s_add_u32 s62, s15, s10
    s_sub_u32 s21, s15, s10
    s_add_u32 s11, s62, 0
    buffer_load_dwordx4 v[104:107], v2, s[24:27], s11 offen sc1
    s_add_u32 s11, s62, 81920
    buffer_load_dwordx4 v[108:111], v2, s[24:27], s11 offen sc1
    s_add_u32 s11, s21, 1024
    buffer_load_dwordx4 v[112:115], v2, s[24:27], s11 offen sc1
    s_add_u32 s11, s21, 82944
    buffer_load_dwordx4 v[116:119], v2, s[24:27], s11 offen sc1
    s_add_u32 s11, s62, 2048
    buffer_load_dwordx4 v[120:123], v2, s[24:27], s11 offen sc1
    s_add_u32 s11, s62, 83968
    buffer_load_dwordx4 v[124:127], v2, s[24:27], s11 offen sc1
    s_add_u32 s11, s21, 3072
    buffer_load_dwordx4 v[128:131], v2, s[24:27], s11 offen sc1
    s_add_u32 s11, s21, 84992
    buffer_load_dwordx4 v[132:135], v2, s[24:27], s11 offen sc1
    s_add_u32 s11, s62, 4096
    buffer_load_dwordx4 v[136:139], v2, s[24:27], s11 offen sc1
    s_add_u32 s11, s62, 86016
    buffer_load_dwordx4 v[140:143], v2, s[24:27], s11 offen sc1
    s_add_u32 s11, s21, 5120
    buffer_load_dwordx4 v[144:147], v2, s[24:27], s11 offen sc1
    s_add_u32 s11, s21, 87040
    buffer_load_dwordx4 v[148:151], v2, s[24:27], s11 offen sc1
    s_add_u32 s11, s62, 6144
    buffer_load_dwordx4 v[152:155], v2, s[24:27], s11 offen sc1
    s_add_u32 s11, s62, 88064
    buffer_load_dwordx4 v[156:159], v2, s[24:27], s11 offen sc1
    s_add_u32 s11, s21, 7168
    buffer_load_dwordx4 v[160:163], v2, s[24:27], s11 offen sc1
    s_add_u32 s11, s21, 89088
    buffer_load_dwordx4 v[164:167], v2, s[24:27], s11 offen sc1
    ds_write_b128 v1, v[16:19] offset:0
    ds_write_b128 v1, v[20:23] offset:10496
    ds_write_b128 v1, v[24:27] offset:64
    ds_write_b128 v1, v[28:31] offset:10560
    ds_write_b128 v1, v[32:35] offset:128
    ds_write_b128 v1, v[36:39] offset:10624
    ds_write_b128 v1, v[40:43] offset:192
    ds_write_b128 v1, v[44:47] offset:10688
    ds_write_b128 v1, v[48:51] offset:256
    ds_write_b128 v1, v[52:55] offset:10752
    ds_write_b128 v1, v[56:59] offset:320
    ds_write_b128 v1, v[60:63] offset:10816
    s_waitcnt lgkmcnt(6)
    ds_write_b128 v1, v[64:67] offset:384
    ds_write_b128 v1, v[68:71] offset:10880
    ds_write_b128 v1, v[72:75] offset:448
    ds_write_b128 v1, v[76:79] offset:10944
    ds_write_b128 v1, v[80:83] offset:512
    ds_write_b128 v1, v[84:87] offset:11008
    ds_write_b128 v1, v[88:91] offset:576
    ds_write_b128 v1, v[92:95] offset:11072
    s_lshr_b32 s10, s58, 1
    s_add_u32 s21, s10, 8
    s_sub_u32 s10, s21, s58
    s_mul_i32 s10, s10, 20480
    s_add_u32 s62, s62, s10
    s_waitcnt lgkmcnt(0)
    s_add_u32 s11, s62, -12288
    buffer_load_dwordx4 v[64:67], v2, s[24:27], s11 offen sc1
    s_add_u32 s11, s62, -10240
    buffer_load_dwordx4 v[68:71], v2, s[24:27], s11 offen sc1
    s_add_u32 s11, s62, -8192
    buffer_load_dwordx4 v[72:75], v2, s[24:27], s11 offen sc1
    s_add_u32 s11, s62, -6144
    buffer_load_dwordx4 v[76:79], v2, s[24:27], s11 offen sc1
    s_add_u32 s11, s62, -4096
    buffer_load_dwordx4 v[80:83], v2, s[24:27], s11 offen sc1
    s_add_u32 s11, s62, -2048
    buffer_load_dwordx4 v[84:87], v2, s[24:27], s11 offen sc1
    s_add_u32 s11, s62, 0
    buffer_load_dwordx4 v[88:91], v2, s[24:27], s11 offen sc1
    s_add_u32 s11, s62, 2048
    buffer_load_dwordx4 v[92:95], v2, s[24:27], s11 offen sc1
    s_add_u32 s11, s62, 4096
    buffer_load_dwordx4 v[96:99], v2, s[24:27], s11 offen sc1
    s_add_u32 s11, s62, 6144
    buffer_load_dwordx4 v[100:103], v2, s[24:27], s11 offen sc1
    s_setprio 3
    v_mov_b32 v10, v8
    v_lshrrev_b32 v8, 4, v0
    s_lshl_b32 s10, s20, 11
    v_add_u32 v3, s10, v12
    v_subrev_u32 v4, s10, v12
    v_add_u32 v4, 2048, v4
    v_lshrrev_b32 v7, 1, v12
    v_lshl_add_u32 v7, v8, 8, v7
    v_add_u32 v5, s10, v7
    v_subrev_u32 v6, s10, v7
    v_add_u32 v6, 2048, v6
    s_mul_i32 s10, s58, 20992
    s_add_u32 s10, s10, 26624
    s_mul_i32 s11, s20, 20992
    s_lshl_b32 s21, s21, 6
    s_add_u32 s11, s11, s21
    s_sub_u32 s11, s11, s10
    v_add_u32 v9, s11, v1
    s_lshl_b32 s11, s58, 6
    s_add_u32 s11, s11, 41984
    s_sub_u32 s11, s11, s10
    v_add_u32 v1, s11, v1
    v_mov_b32 v12, 0
    v_mov_b32 v13, 0
    v_mov_b32 v14, 0
    v_mov_b32 v15, 0
    v_and_b32 v8, 16, v2
    v_add_u32 v8, 103936, v8
    s_and_b32 s11, s2, 7
    s_lshl_b32 s11, s11, 7
    s_add_u32 s11, s11, 22216712
    v_lshl_add_u32 v7, v0, 10, s11
    v_add_u32 v11, 32768, v11
    s_lshl_b32 s11, s13, 12
    s_add_u32 s11, s11, 22413312
    v_lshl_add_u32 v7, v0, 7, s11
    s_barrier
    s_waitcnt vmcnt(0)
    s_barrier
    s_cmp_lg_u32 s58, 3
    s_cbranch_scc1 L3_nopoll
    s_mov_b32 exec_hi, 0
    s_mov_b32 s10, 262144
L3_poll:
    buffer_load_dword v11, v7, s[24:27], 0 offen sc1
    s_sub_u32 s10, s10, 1
    s_waitcnt vmcnt(0)
    v_cmp_ne_u32 vcc, v10, v11
    s_cbranch_scc1 L3_poll_x
    s_cbranch_vccnz L3_poll
L3_poll_x:
    s_mov_b64 exec, -1
    s_mul_i32 s11, s13, 40960
    s_mov_b32 m0, 0
    s_add_u32 s10, s11, 16777216
    buffer_load_dwordx4 v2, s[24:27], s10 offen offset:0 sc1 lds
    buffer_load_dwordx4 v2, s[24:27], s10 offen offset:1024 sc1 lds
    buffer_load_dwordx4 v2, s[24:27], s10 offen offset:2048 sc1 lds
    buffer_load_dwordx4 v2, s[24:27], s10 offen offset:3072 sc1 lds
    s_mov_b32 m0, 4096
    s_add_u32 s10, s11, 16781312
    buffer_load_dwordx4 v2, s[24:27], s10 offen offset:0 sc1 lds
    buffer_load_dwordx4 v2, s[24:27], s10 offen offset:1024 sc1 lds
    buffer_load_dwordx4 v2, s[24:27], s10 offen offset:2048 sc1 lds
    buffer_load_dwordx4 v2, s[24:27], s10 offen offset:3072 sc1 lds
    s_mov_b32 m0, 8192
    s_add_u32 s10, s11, 16785408
    buffer_load_dwordx4 v2, s[24:27], s10 offen offset:0 sc1 lds
    buffer_load_dwordx4 v2, s[24:27], s10 offen offset:1024 sc1 lds
    buffer_load_dwordx4 v2, s[24:27], s10 offen offset:2048 sc1 lds
    buffer_load_dwordx4 v2, s[24:27], s10 offen offset:3072 sc1 lds
    s_mov_b32 m0, 12288
    s_add_u32 s10, s11, 16789504
    buffer_load_dwordx4 v2, s[24:27], s10 offen offset:0 sc1 lds
    buffer_load_dwordx4 v2, s[24:27], s10 offen offset:1024 sc1 lds
    buffer_load_dwordx4 v2, s[24:27], s10 offen offset:2048 sc1 lds
    buffer_load_dwordx4 v2, s[24:27], s10 offen offset:3072 sc1 lds
    s_mov_b32 m0, 16384
    s_add_u32 s10, s11, 16793600
    buffer_load_dwordx4 v2, s[24:27], s10 offen offset:0 sc1 lds
    buffer_load_dwordx4 v2, s[24:27], s10 offen offset:1024 sc1 lds
    buffer_load_dwordx4 v2, s[24:27], s10 offen offset:2048 sc1 lds
    buffer_load_dwordx4 v2, s[24:27], s10 offen offset:3072 sc1 lds
    s_mov_b32 m0, 20480
    s_add_u32 s10, s11, 16797696
    buffer_load_dwordx4 v2, s[24:27], s10 offen offset:0 sc1 lds
    buffer_load_dwordx4 v2, s[24:27], s10 offen offset:1024 sc1 lds
    buffer_load_dwordx4 v2, s[24:27], s10 offen offset:2048 sc1 lds
    buffer_load_dwordx4 v2, s[24:27], s10 offen offset:3072 sc1 lds
    s_mov_b32 m0, 24576
    s_add_u32 s10, s11, 16801792
    buffer_load_dwordx4 v2, s[24:27], s10 offen offset:0 sc1 lds
    buffer_load_dwordx4 v2, s[24:27], s10 offen offset:1024 sc1 lds
    buffer_load_dwordx4 v2, s[24:27], s10 offen offset:2048 sc1 lds
    buffer_load_dwordx4 v2, s[24:27], s10 offen offset:3072 sc1 lds
    s_mov_b32 m0, 28672
    s_add_u32 s10, s11, 16805888
    buffer_load_dwordx4 v2, s[24:27], s10 offen offset:0 sc1 lds
    buffer_load_dwordx4 v2, s[24:27], s10 offen offset:1024 sc1 lds
    buffer_load_dwordx4 v2, s[24:27], s10 offen offset:2048 sc1 lds
    buffer_load_dwordx4 v2, s[24:27], s10 offen offset:3072 sc1 lds
    s_mov_b32 m0, 32768
    s_add_u32 s10, s11, 16809984
    buffer_load_dwordx4 v2, s[24:27], s10 offen offset:0 sc1 lds
    buffer_load_dwordx4 v2, s[24:27], s10 offen offset:1024 sc1 lds
    buffer_load_dwordx4 v2, s[24:27], s10 offen offset:2048 sc1 lds
    buffer_load_dwordx4 v2, s[24:27], s10 offen offset:3072 sc1 lds
    s_mov_b32 m0, 36864
    s_add_u32 s10, s11, 16814080
    buffer_load_dwordx4 v2, s[24:27], s10 offen offset:0 sc1 lds
    buffer_load_dwordx4 v2, s[24:27], s10 offen offset:1024 sc1 lds
    buffer_load_dwordx4 v2, s[24:27], s10 offen offset:2048 sc1 lds
    buffer_load_dwordx4 v2, s[24:27], s10 offen offset:3072 sc1 lds
L3_nopoll:
    s_setprio 3
    s_waitcnt vmcnt(28)
    s_barrier
    ds_read_b128 v[16:19], v3 offset:0
    ds_read_b128 v[20:23], v3 offset:256
    ds_read_b128 v[24:27], v3 offset:4096
    ds_read_b128 v[28:31], v3 offset:4352
    ds_read_b128 v[32:35], v3 offset:8192
    ds_read_b128 v[36:39], v3 offset:8448
    s_waitcnt lgkmcnt(4)
    v_mfma_f32_16x16x32_bf16 v[40:43], v[64:67], v[16:19], 0
    v_mfma_f32_16x16x32_bf16 v[44:47], v[64:67], v[20:23], 0
    s_waitcnt lgkmcnt(2)
    v_mfma_f32_16x16x32_bf16 v[40:43], v[68:71], v[24:27], v[40:43]
    v_mfma_f32_16x16x32_bf16 v[44:47], v[68:71], v[28:31], v[44:47]
    s_waitcnt lgkmcnt(0)
    v_mfma_f32_16x16x32_bf16 v[40:43], v[72:75], v[32:35], v[40:43]
    v_mfma_f32_16x16x32_bf16 v[44:47], v[72:75], v[36:39], v[44:47]
    s_waitcnt vmcnt(0)
    s_barrier
    ds_read_b128 v[16:19], v3 offset:12288
    ds_read_b128 v[20:23], v3 offset:12544
    ds_read_b128 v[24:27], v3 offset:16384
    ds_read_b128 v[28:31], v3 offset:16640
    s_waitcnt lgkmcnt(2)
    v_mfma_f32_16x16x32_bf16 v[40:43], v[76:79], v[16:19], v[40:43]
    ds_read_b128 v[32:35], v3 offset:20480
    v_mfma_f32_16x16x32_bf16 v[44:47], v[76:79], v[20:23], v[44:47]
    ds_read_b128 v[36:39], v3 offset:20736
    s_waitcnt lgkmcnt(2)
    v_mfma_f32_16x16x32_bf16 v[40:43], v[80:83], v[24:27], v[40:43]
    ds_read_b128 v[16:19], v3 offset:24576
    v_mfma_f32_16x16x32_bf16 v[44:47], v[80:83], v[28:31], v[44:47]
    ds_read_b128 v[20:23], v3 offset:24832
    s_waitcnt lgkmcnt(2)
    v_mfma_f32_16x16x32_bf16 v[40:43], v[84:87], v[32:35], v[40:43]
    ds_read_b128 v[24:27], v4 offset:24576
    v_mfma_f32_16x16x32_bf16 v[44:47], v[84:87], v[36:39], v[44:47]
    ds_read_b128 v[28:31], v4 offset:24832
    s_waitcnt lgkmcnt(2)
    v_mfma_f32_16x16x32_bf16 v[48:51], v[104:107], v[16:19], 0
    ds_read_b128 v[32:35], v3 offset:28672
    v_mfma_f32_16x16x32_bf16 v[56:59], v[108:111], v[16:19], 0
    v_mfma_f32_16x16x32_bf16 v[52:55], v[104:107], v[20:23], 0
    v_mfma_f32_16x16x32_bf16 v[60:63], v[108:111], v[20:23], 0
    ds_read_b128 v[36:39], v3 offset:28928
    v_mfma_f32_16x16x32_bf16 v[40:43], v[88:91], v[16:19], v[40:43]
    v_mfma_f32_16x16x32_bf16 v[44:47], v[88:91], v[20:23], v[44:47]
    s_waitcnt lgkmcnt(2)
    v_mfma_f32_16x16x32_bf16 v[48:51], v[112:115], v[24:27], v[48:51]
    ds_read_b128 v[16:19], v4 offset:28672
    v_mfma_f32_16x16x32_bf16 v[56:59], v[116:119], v[24:27], v[56:59]
    v_mfma_f32_16x16x32_bf16 v[52:55], v[112:115], v[28:31], v[52:55]
    ds_read_b128 v[20:23], v4 offset:28928
    v_mfma_f32_16x16x32_bf16 v[60:63], v[116:119], v[28:31], v[60:63]
    s_waitcnt lgkmcnt(2)
    v_mfma_f32_16x16x32_bf16 v[48:51], v[120:123], v[32:35], v[48:51]
    ds_read_b64 v[24:25], v5 offset:32768
    v_mfma_f32_16x16x32_bf16 v[56:59], v[124:127], v[32:35], v[56:59]
    ds_read_b64 v[26:27], v5 offset:33024
    v_mfma_f32_16x16x32_bf16 v[52:55], v[120:123], v[36:39], v[52:55]
    v_mfma_f32_16x16x32_bf16 v[60:63], v[124:127], v[36:39], v[60:63]
    ds_read_b64 v[28:29], v5 offset:32896
    v_mfma_f32_16x16x32_bf16 v[40:43], v[92:95], v[32:35], v[40:43]
    ds_read_b64 v[30:31], v5 offset:33152
    v_mfma_f32_16x16x32_bf16 v[44:47], v[92:95], v[36:39], v[44:47]
    s_waitcnt lgkmcnt(4)
    v_mfma_f32_16x16x32_bf16 v[48:51], v[128:131], v[16:19], v[48:51]
    ds_read_b64 v[32:33], v6 offset:32768
    v_mfma_f32_16x16x32_bf16 v[56:59], v[132:135], v[16:19], v[56:59]
    ds_read_b64 v[34:35], v6 offset:33024
    v_mfma_f32_16x16x32_bf16 v[52:55], v[128:131], v[20:23], v[52:55]
    ds_read_b64 v[36:37], v6 offset:32896
    v_mfma_f32_16x16x32_bf16 v[60:63], v[132:135], v[20:23], v[60:63]
    ds_read_b64 v[38:39], v6 offset:33152
    s_waitcnt lgkmcnt(4)
    v_mfma_f32_16x16x32_bf16 v[48:51], v[136:139], v[24:27], v[48:51]
    ds_read_b64 v[16:17], v5 offset:36864
    v_mfma_f32_16x16x32_bf16 v[56:59], v[140:143], v[24:27], v[56:59]
    ds_read_b64 v[18:19], v5 offset:37120
    v_mfma_f32_16x16x32_bf16 v[52:55], v[136:139], v[28:31], v[52:55]
    v_mfma_f32_16x16x32_bf16 v[60:63], v[140:143], v[28:31], v[60:63]
    ds_read_b64 v[20:21], v5 offset:36992
    v_mfma_f32_16x16x32_bf16 v[40:43], v[96:99], v[24:27], v[40:43]
    ds_read_b64 v[22:23], v5 offset:37248
    v_mfma_f32_16x16x32_bf16 v[44:47], v[96:99], v[28:31], v[44:47]
    s_waitcnt lgkmcnt(4)
    v_mfma_f32_16x16x32_bf16 v[48:51], v[144:147], v[32:35], v[48:51]
    ds_read_b64 v[24:25], v6 offset:36864
    v_mfma_f32_16x16x32_bf16 v[56:59], v[148:151], v[32:35], v[56:59]
    ds_read_b64 v[26:27], v6 offset:37120
    v_mfma_f32_16x16x32_bf16 v[52:55], v[144:147], v[36:39], v[52:55]
    ds_read_b64 v[28:29], v6 offset:36992
    v_mfma_f32_16x16x32_bf16 v[60:63], v[148:151], v[36:39], v[60:63]
    ds_read_b64 v[30:31], v6 offset:37248
    s_waitcnt lgkmcnt(4)
    v_mfma_f32_16x16x32_bf16 v[48:51], v[152:155], v[16:19], v[48:51]
    v_mfma_f32_16x16x32_bf16 v[56:59], v[156:159], v[16:19], v[56:59]
    v_mfma_f32_16x16x32_bf16 v[52:55], v[152:155], v[20:23], v[52:55]
    v_mfma_f32_16x16x32_bf16 v[60:63], v[156:159], v[20:23], v[60:63]
    v_mfma_f32_16x16x32_bf16 v[40:43], v[100:103], v[16:19], v[40:43]
    v_mfma_f32_16x16x32_bf16 v[44:47], v[100:103], v[20:23], v[44:47]
    s_waitcnt lgkmcnt(0)
    v_mfma_f32_16x16x32_bf16 v[48:51], v[160:163], v[24:27], v[48:51]
    v_mfma_f32_16x16x32_bf16 v[56:59], v[164:167], v[24:27], v[56:59]
    v_mfma_f32_16x16x32_bf16 v[52:55], v[160:163], v[28:31], v[52:55]
    v_mfma_f32_16x16x32_bf16 v[60:63], v[164:167], v[28:31], v[60:63]
    s_mov_b64 exec, 3
    ds_write_b128 v8, v[12:15]
    s_mov_b64 exec, -1
    ds_write_b128 v9, v[40:43] offset:0
    ds_write_b128 v9, v[44:47] offset:10496
    ds_write_b128 v1, v[48:51] offset:0
    ds_write_b128 v1, v[56:59] offset:256
    ds_write_b128 v1, v[52:55] offset:10496
    ds_write_b128 v1, v[60:63] offset:10752
    s_waitcnt lgkmcnt(0)
    s_barrier
    s_branch L3_done
L_end:
    s_endpgm
L1_compute:
    v_lshrrev_b32 v1, 4, v0
    s_cmp_ge_u32 s3, 4
    s_cbranch_scc1 L1_g1
    s_waitcnt lgkmcnt(0)
    s_mov_b32 s24, s22
    s_mov_b32 s25, s23
    s_mov_b32 s26, 22675456
    s_mov_b32 s27, 0x00020000
    s_mov_b32 s28, s4
    s_mov_b32 s29, s5
    s_mov_b32 s30, 2621440
    s_mov_b32 s31, 0x00020000
    s_lshl_b32 s50, s2, 4
    s_add_u32 s50, s50, s3
    s_cmp_lg_u32 s50, 1
    s_cbranch_scc1 L1_notag0
    v_mov_b32 v166, 22183936
    s_mov_b64 exec, 1
    buffer_load_dword v166, v166, s[24:27], 0 offen sc1
    s_mov_b64 exec, -1
L1_notag0:
    s_and_b32 s58, s3, 1
    s_bfe_u32 s59, s3, 0x10001
    s_lshl_b32 s63, s52, 1
    s_add_u32 s63, s63, s59
    s_lshl_b32 s63, s63, 1
    s_lshl_b32 s64, s58, 1
    s_mov_b32 s61, 0
    s_mov_b32 s62, 5
    s_mov_b32 s32, s18
    s_mov_b32 s33, s19
    s_mov_b32 s34, 2621440
    s_mov_b32 s35, 0x00020000
    s_and_b32 s11, s2, 7
    s_lshr_b32 s10, s2, 3
    s_and_b32 s7, s10, 7
    s_and_b32 s14, s10, 3
    s_lshr_b32 s13, s10, 2
    s_lshl_b32 s6, s11, 3
    s_add_u32 s13, s13, s6
    s_lshr_b32 s10, s10, 3
    s_lshl_b32 s11, s11, 2
    s_add_u32 s6, s11, s10
    s_and_b32 s8, s6, 1
    s_lshr_b32 s11, s6, 1
    s_mul_i32 s11, s11, 5
    s_add_u32 s12, s11, 2
    s_mul_i32 s10, s8, 3
    s_add_u32 s9, s11, s10
    s_and_b32 s16, s3, 3
    s_mul_i32 s15, s14, 10
    s_add_u32 s15, s15, s16
    s_mul_i32 s15, s15, 20
    s_lshr_b32 s11, s3, 2
    s_mul_i32 s11, s11, 6
    s_add_u32 s15, s15, s11
    s_lshl_b32 s15, s15, 10
    s_add_u32 s15, s15, 21364736
    s_mul_i32 s17, s13, 40960
    s_mul_i32 s11, s14, 320
    s_add_u32 s17, s17, s11
    s_mov_b32 s4, 0x000fffff
    s_mov_b32 s5, 0x000fffff
    s_lshl_b32 s18, s7, 3
    s_add_u32 s18, s18, s3
    s_lshr_b32 s47, s3, 1
    s_mul_i32 s47, s47, 3072
    s_and_b32 s11, s3, 1
    s_lshl_b32 s45, s11, 10
    s_add_u32 s45, s45, s47
    s_lshl_b32 s11, s11, 9
    s_add_u32 s47, s47, s11
    s_mov_b32 s19, 0
    s_mov_b32 s44, 8
    v_lshrrev_b32 v4, 4, v0
    v_lshlrev_b32 v2, 10, v4
    v_xor_b32 v4, s64, v4
    v_and_b32 v4, 1, v4
    v_lshl_add_u32 v2, v4, 5, v2
    v_bfe_u32 v4, v0, 2, 2
    v_lshl_add_u32 v2, v4, 6, v2
    v_and_b32 v4, 3, v0
    v_lshl_add_u32 v2, v4, 3, v2
    s_lshr_b32 s10, s64, 1
    s_lshl_b32 s10, s10, 8
    v_add_u32 v2, s10, v2
    v_and_b32 v4, 15, v0
    v_bfe_u32 v5, v0, 1, 3
    v_xor_b32 v5, v5, v1
    v_lshlrev_b32 v5, 4, v5
    v_lshl_add_u32 v5, v4, 7, v5
    s_lshl_b32 s10, s59, 13
    v_add_u32 v5, s10, v5
    v_mov_b32 v8, 0
    v_mov_b32 v9, 0
    v_mov_b32 v10, 0
    v_mov_b32 v11, 0
    v_mov_b32 v12, 0
    v_mov_b32 v13, 0
    v_mov_b32 v14, 0
    v_mov_b32 v15, 0
    v_mov_b32 v16, 0
    v_mov_b32 v17, 0
    v_mov_b32 v18, 0
    v_mov_b32 v19, 0
    v_mov_b32 v20, 0
    v_mov_b32 v21, 0
    v_mov_b32 v22, 0
    v_mov_b32 v23, 0
    v_mov_b32 v24, 0
    v_mov_b32 v25, 0
    v_mov_b32 v26, 0
    v_mov_b32 v27, 0
    v_mov_b32 v28, 0
    v_mov_b32 v29, 0
    v_mov_b32 v30, 0
    v_mov_b32 v31, 0
    v_mov_b32 v32, 0
    v_mov_b32 v33, 0
    v_mov_b32 v34, 0
    v_mov_b32 v35, 0
    v_mov_b32 v36, 0
    v_mov_b32 v37, 0
    v_mov_b32 v38, 0
    v_mov_b32 v39, 0
    v_mov_b32 v40, 0
    v_mov_b32 v41, 0
    v_mov_b32 v42, 0
    v_mov_b32 v43, 0
    v_mov_b32 v44, 0
    v_mov_b32 v45, 0
    v_mov_b32 v46, 0
    v_mov_b32 v47, 0
    v_mov_b32 v48, 0
    v_mov_b32 v49, 0
    v_mov_b32 v50, 0
    v_mov_b32 v51, 0
    v_mov_b32 v52, 0
    v_mov_b32 v53, 0
    v_mov_b32 v54, 0
    v_mov_b32 v55, 0
    v_mov_b32 v56, 0
    v_mov_b32 v57, 0
    v_mov_b32 v58, 0
    v_mov_b32 v59, 0
    v_mov_b32 v60, 0
    v_mov_b32 v61, 0
    v_mov_b32 v62, 0
    v_mov_b32 v63, 0
    v_mov_b32 v64, 0
    v_mov_b32 v65, 0
    v_mov_b32 v66, 0
    v_mov_b32 v67, 0
    v_mov_b32 v68, 0
    v_mov_b32 v69, 0
    v_mov_b32 v70, 0
    v_mov_b32 v71, 0
    v_mov_b32 v72, 0
    v_mov_b32 v73, 0
    v_mov_b32 v74, 0
    v_mov_b32 v75, 0
    v_mov_b32 v76, 0
    v_mov_b32 v77, 0
    v_mov_b32 v78, 0
    v_mov_b32 v79, 0
    v_mov_b32 v80, 0
    v_mov_b32 v81, 0
    v_mov_b32 v82, 0
    v_mov_b32 v83, 0
    v_mov_b32 v84, 0
    v_mov_b32 v85, 0
    v_mov_b32 v86, 0
    v_mov_b32 v87, 0
    v_mov_b32 v88, 0
    v_mov_b32 v89, 0
    v_mov_b32 v90, 0
    v_mov_b32 v91, 0
    v_mov_b32 v92, 0
    v_mov_b32 v93, 0
    v_mov_b32 v94, 0
    v_mov_b32 v95, 0
    v_mov_b32 v96, 0
    v_mov_b32 v97, 0
    v_mov_b32 v98, 0
    v_mov_b32 v99, 0
    v_mov_b32 v100, 0
    v_mov_b32 v101, 0
    v_mov_b32 v102, 0
    v_mov_b32 v103, 0
    s_cmp_lg_u32 s50, 1
    s_cbranch_scc1 L1_notag
    s_mov_b32 s36, s20
    s_mov_b32 s37, s21
    s_mov_b32 s38, 256
    s_mov_b32 s39, 0x00020000
    s_mov_b64 exec, 1
    s_mov_b32 s10, 0x9e3779b1
    s_waitcnt vmcnt(0)
    v_mul_lo_u32 v3, v166, s10
    v_add_u32 v3, 0x7f4a7c15, v3
    v_or_b32 v166, 2, v3
    buffer_store_dword v166, v8, s[36:39], 0 offen sc1
    s_mov_b64 exec, -1
L1_notag:
    s_lshl_b32 s67, s53, 4
    s_add_u32 s67, s67, s52
    s_mul_i32 s67, s67, 128
    s_add_u32 s67, s67, 22249472
    v_and_b32 v3, 15, v0
    s_lshl_b32 s10, s59, 9
    s_add_u32 s10, s10, 161024
    v_lshl_add_u32 v162, v3, 3, s10
    v_lshl_add_u32 v163, v1, 5, s10
    s_lshl_b32 s11, s58, 7
    s_add_u32 s11, s11, 159744
    v_lshl_add_u32 v164, v1, 4, s11
    v_lshl_add_u32 v165, v3, 2, s11
    v_mov_b32 v1, 162048
    v_and_b32 v4, 7, v0
    v_lshl_add_u32 v4, v4, 2, v1
    ds_write_b32 v4, v8
    s_mov_b32 s60, 98304
    s_waitcnt lgkmcnt(0)
    s_setprio 2
    v_add_u32 v3, s60, v2
    v_xor_b32 v4, 32, v3
    v_add_u32 v6, s61, v5
    v_xor_b32 v7, 64, v6
    s_add_u32 s60, s60, 12288
    s_cmp_eq_u32 s60, 159744
    s_cselect_b32 s60, 98304, s60
    s_add_u32 s61, s61, 16384
    s_cmp_eq_u32 s61, 98304
    s_cselect_b32 s61, 0, s61
    s_barrier
    ds_read_b128 v[104:107], v6 offset:0
    ds_read_b128 v[108:111], v6 offset:2048
    ds_read_b128 v[112:115], v6 offset:4096
    ds_read_b128 v[116:119], v6 offset:6144
    ds_read_b64_tr_b16 v[136:137], v3 offset:0
    ds_read_b64_tr_b16 v[138:139], v3 offset:512
    ds_read_b64_tr_b16 v[140:141], v4 offset:0
    ds_read_b64_tr_b16 v[142:143], v4 offset:512
    ds_read_b64_tr_b16 v[144:145], v3 offset:4096
    ds_read_b64_tr_b16 v[146:147], v3 offset:4608
    ds_read_b64_tr_b16 v[148:149], v4 offset:4096
    ds_read_b64_tr_b16 v[150:151], v4 offset:4608
    ds_read_b64_tr_b16 v[152:153], v3 offset:8192
    ds_read_b64_tr_b16 v[154:155], v3 offset:8704
    s_waitcnt lgkmcnt(8)
    s_cmp_lt_u32 s57, 20
    s_cbranch_scc0 L1_aN
L1_aT:
    v_mfma_f32_16x16x32_bf16 v[8:11], v[136:139], v[104:107], v[8:11]
    ds_read_b64_tr_b16 v[156:157], v4 offset:8192
    v_mfma_f32_16x16x32_bf16 v[12:15], v[136:139], v[108:111], v[12:15]
    ds_read_b64_tr_b16 v[158:159], v4 offset:8704
    v_mfma_f32_16x16x32_bf16 v[16:19], v[136:139], v[112:115], v[16:19]
    s_barrier
    v_mfma_f32_16x16x32_bf16 v[20:23], v[136:139], v[116:119], v[20:23]
    s_waitcnt lgkmcnt(8)
    v_mfma_f32_16x16x32_bf16 v[36:39], v[140:143], v[116:119], v[36:39]
    ds_read_b128 v[120:123], v7 offset:0
    v_add_u32 v3, s60, v2
    v_mfma_f32_16x16x32_bf16 v[32:35], v[140:143], v[112:115], v[32:35]
    ds_read_b128 v[124:127], v7 offset:2048
    v_xor_b32 v4, 32, v3
    v_mfma_f32_16x16x32_bf16 v[28:31], v[140:143], v[108:111], v[28:31]
    ds_read_b128 v[128:131], v7 offset:4096
    v_mfma_f32_16x16x32_bf16 v[24:27], v[140:143], v[104:107], v[24:27]
    ds_read_b128 v[132:135], v7 offset:6144
    s_waitcnt lgkmcnt(10)
    v_mfma_f32_16x16x32_bf16 v[40:43], v[144:147], v[104:107], v[40:43]
    ds_read_b64_tr_b16 v[136:137], v3 offset:0
    s_add_u32 s60, s60, 12288
    v_mfma_f32_16x16x32_bf16 v[44:47], v[144:147], v[108:111], v[44:47]
    ds_read_b64_tr_b16 v[138:139], v3 offset:512
    s_cmp_eq_u32 s60, 159744
    v_mfma_f32_16x16x32_bf16 v[48:51], v[144:147], v[112:115], v[48:51]
    ds_read_b64_tr_b16 v[140:141], v4 offset:0
    s_cselect_b32 s60, 98304, s60
    v_mfma_f32_16x16x32_bf16 v[52:55], v[144:147], v[116:119], v[52:55]
    ds_read_b64_tr_b16 v[142:143], v4 offset:512
    s_waitcnt lgkmcnt(12)
    v_mfma_f32_16x16x32_bf16 v[68:71], v[148:151], v[116:119], v[68:71]
    ds_read_b64_tr_b16 v[144:145], v3 offset:4096
    v_add_u32 v6, s61, v5
    v_mfma_f32_16x16x32_bf16 v[64:67], v[148:151], v[112:115], v[64:67]
    ds_read_b64_tr_b16 v[146:147], v3 offset:4608
    v_xor_b32 v7, 64, v6
    v_mfma_f32_16x16x32_bf16 v[60:63], v[148:151], v[108:111], v[60:63]
    v_mfma_f32_16x16x32_bf16 v[56:59], v[148:151], v[104:107], v[56:59]
    s_waitcnt lgkmcnt(12)
    v_mfma_f32_16x16x32_bf16 v[72:75], v[152:155], v[104:107], v[72:75]
    ds_read_b64_tr_b16 v[148:149], v4 offset:4096
    v_mfma_f32_16x16x32_bf16 v[76:79], v[152:155], v[108:111], v[76:79]
    ds_read_b64_tr_b16 v[150:151], v4 offset:4608
    v_mfma_f32_16x16x32_bf16 v[80:83], v[152:155], v[112:115], v[80:83]
    v_mfma_f32_16x16x32_bf16 v[84:87], v[152:155], v[116:119], v[84:87]
    s_waitcnt lgkmcnt(12)
    v_mfma_f32_16x16x32_bf16 v[100:103], v[156:159], v[116:119], v[100:103]
    ds_read_b64_tr_b16 v[152:153], v3 offset:8192
    v_mfma_f32_16x16x32_bf16 v[96:99], v[156:159], v[112:115], v[96:99]
    ds_read_b64_tr_b16 v[154:155], v3 offset:8704
    v_mfma_f32_16x16x32_bf16 v[92:95], v[156:159], v[108:111], v[92:95]
    v_mfma_f32_16x16x32_bf16 v[88:91], v[156:159], v[104:107], v[88:91]
    s_waitcnt lgkmcnt(8)
    v_mfma_f32_16x16x32_bf16 v[8:11], v[136:139], v[120:123], v[8:11]
    ds_read_b64_tr_b16 v[156:157], v4 offset:8192
    v_mfma_f32_16x16x32_bf16 v[12:15], v[136:139], v[124:127], v[12:15]
    ds_read_b64_tr_b16 v[158:159], v4 offset:8704
    v_mfma_f32_16x16x32_bf16 v[16:19], v[136:139], v[128:131], v[16:19]
    s_barrier
    v_mfma_f32_16x16x32_bf16 v[20:23], v[136:139], v[132:135], v[20:23]
    s_waitcnt lgkmcnt(8)
    v_mfma_f32_16x16x32_bf16 v[36:39], v[140:143], v[132:135], v[36:39]
    ds_read_b128 v[104:107], v6 offset:0
    v_add_u32 v3, s60, v2
    v_mfma_f32_16x16x32_bf16 v[32:35], v[140:143], v[128:131], v[32:35]
    ds_read_b128 v[108:111], v6 offset:2048
    v_xor_b32 v4, 32, v3
    v_mfma_f32_16x16x32_bf16 v[28:31], v[140:143], v[124:127], v[28:31]
    ds_read_b128 v[112:115], v6 offset:4096
    v_mfma_f32_16x16x32_bf16 v[24:27], v[140:143], v[120:123], v[24:27]
    ds_read_b128 v[116:119], v6 offset:6144
    s_waitcnt lgkmcnt(10)
    v_mfma_f32_16x16x32_bf16 v[40:43], v[144:147], v[120:123], v[40:43]
    ds_read_b64_tr_b16 v[136:137], v3 offset:0
    s_add_u32 s60, s60, 12288
    v_mfma_f32_16x16x32_bf16 v[44:47], v[144:147], v[124:127], v[44:47]
    ds_read_b64_tr_b16 v[138:139], v3 offset:512
    s_cmp_eq_u32 s60, 159744
    v_mfma_f32_16x16x32_bf16 v[48:51], v[144:147], v[128:131], v[48:51]
    ds_read_b64_tr_b16 v[140:141], v4 offset:0
    s_cselect_b32 s60, 98304, s60
    v_mfma_f32_16x16x32_bf16 v[52:55], v[144:147], v[132:135], v[52:55]
    ds_read_b64_tr_b16 v[142:143], v4 offset:512
    s_waitcnt lgkmcnt(12)
    v_mfma_f32_16x16x32_bf16 v[68:71], v[148:151], v[132:135], v[68:71]
    ds_read_b64_tr_b16 v[144:145], v3 offset:4096
    s_add_u32 s61, s61, 16384
    v_mfma_f32_16x16x32_bf16 v[64:67], v[148:151], v[128:131], v[64:67]
    ds_read_b64_tr_b16 v[146:147], v3 offset:4608
    s_cmp_eq_u32 s61, 98304
    v_mfma_f32_16x16x32_bf16 v[60:63], v[148:151], v[124:127], v[60:63]
    s_cselect_b32 s61, 0, s61
    v_mfma_f32_16x16x32_bf16 v[56:59], v[148:151], v[120:123], v[56:59]
    s_waitcnt lgkmcnt(12)
    v_mfma_f32_16x16x32_bf16 v[72:75], v[152:155], v[120:123], v[72:75]
    ds_read_b64_tr_b16 v[148:149], v4 offset:4096
    v_mfma_f32_16x16x32_bf16 v[76:79], v[152:155], v[124:127], v[76:79]
    ds_read_b64_tr_b16 v[150:151], v4 offset:4608
    v_mfma_f32_16x16x32_bf16 v[80:83], v[152:155], v[128:131], v[80:83]
    v_mfma_f32_16x16x32_bf16 v[84:87], v[152:155], v[132:135], v[84:87]
    s_waitcnt lgkmcnt(12)
    v_mfma_f32_16x16x32_bf16 v[100:103], v[156:159], v[132:135], v[100:103]
    ds_read_b64_tr_b16 v[152:153], v3 offset:8192
    v_mfma_f32_16x16x32_bf16 v[96:99], v[156:159], v[128:131], v[96:99]
    ds_read_b64_tr_b16 v[154:155], v3 offset:8704
    v_mfma_f32_16x16x32_bf16 v[92:95], v[156:159], v[124:127], v[92:95]
    v_mfma_f32_16x16x32_bf16 v[88:91], v[156:159], v[120:123], v[88:91]
    s_waitcnt lgkmcnt(8)
    v_mfma_f32_16x16x32_bf16 v[8:11], v[136:139], v[104:107], v[8:11]
    ds_read_b64_tr_b16 v[156:157], v4 offset:8192
    v_mfma_f32_16x16x32_bf16 v[12:15], v[136:139], v[108:111], v[12:15]
    ds_read_b64_tr_b16 v[158:159], v4 offset:8704
    v_mfma_f32_16x16x32_bf16 v[16:19], v[136:139], v[112:115], v[16:19]
    s_barrier
    v_mfma_f32_16x16x32_bf16 v[20:23], v[136:139], v[116:119], v[20:23]
    s_waitcnt lgkmcnt(8)
    v_mfma_f32_16x16x32_bf16 v[36:39], v[140:143], v[116:119], v[36:39]
    ds_read_b128 v[120:123], v7 offset:0
    v_add_u32 v3, s60, v2
    v_mfma_f32_16x16x32_bf16 v[32:35], v[140:143], v[112:115], v[32:35]
    ds_read_b128 v[124:127], v7 offset:2048
    v_xor_b32 v4, 32, v3
    v_mfma_f32_16x16x32_bf16 v[28:31], v[140:143], v[108:111], v[28:31]
    ds_read_b128 v[128:131], v7 offset:4096
    v_mfma_f32_16x16x32_bf16 v[24:27], v[140:143], v[104:107], v[24:27]
    ds_read_b128 v[132:135], v7 offset:6144
    s_waitcnt lgkmcnt(10)
    v_mfma_f32_16x16x32_bf16 v[40:43], v[144:147], v[104:107], v[40:43]
    ds_read_b64_tr_b16 v[136:137], v3 offset:0
    s_add_u32 s60, s60, 12288
    v_mfma_f32_16x16x32_bf16 v[44:47], v[144:147], v[108:111], v[44:47]
    ds_read_b64_tr_b16 v[138:139], v3 offset:512
    s_cmp_eq_u32 s60, 159744
    v_mfma_f32_16x16x32_bf16 v[48:51], v[144:147], v[112:115], v[48:51]
    ds_read_b64_tr_b16 v[140:141], v4 offset:0
    s_cselect_b32 s60, 98304, s60
    v_mfma_f32_16x16x32_bf16 v[52:55], v[144:147], v[116:119], v[52:55]
    ds_read_b64_tr_b16 v[142:143], v4 offset:512
    s_waitcnt lgkmcnt(12)
    v_mfma_f32_16x16x32_bf16 v[68:71], v[148:151], v[116:119], v[68:71]
    ds_read_b64_tr_b16 v[144:145], v3 offset:4096
    v_add_u32 v6, s61, v5
    v_mfma_f32_16x16x32_bf16 v[64:67], v[148:151], v[112:115], v[64:67]
    ds_read_b64_tr_b16 v[146:147], v3 offset:4608
    v_xor_b32 v7, 64, v6
    v_mfma_f32_16x16x32_bf16 v[60:63], v[148:151], v[108:111], v[60:63]
    v_mfma_f32_16x16x32_bf16 v[56:59], v[148:151], v[104:107], v[56:59]
    s_waitcnt lgkmcnt(12)
    v_mfma_f32_16x16x32_bf16 v[72:75], v[152:155], v[104:107], v[72:75]
    ds_read_b64_tr_b16 v[148:149], v4 offset:4096
    v_mfma_f32_16x16x32_bf16 v[76:79], v[152:155], v[108:111], v[76:79]
    ds_read_b64_tr_b16 v[150:151], v4 offset:4608
    v_mfma_f32_16x16x32_bf16 v[80:83], v[152:155], v[112:115], v[80:83]
    v_mfma_f32_16x16x32_bf16 v[84:87], v[152:155], v[116:119], v[84:87]
    s_waitcnt lgkmcnt(12)
    v_mfma_f32_16x16x32_bf16 v[100:103], v[156:159], v[116:119], v[100:103]
    ds_read_b64_tr_b16 v[152:153], v3 offset:8192
    v_mfma_f32_16x16x32_bf16 v[96:99], v[156:159], v[112:115], v[96:99]
    ds_read_b64_tr_b16 v[154:155], v3 offset:8704
    v_mfma_f32_16x16x32_bf16 v[92:95], v[156:159], v[108:111], v[92:95]
    v_mfma_f32_16x16x32_bf16 v[88:91], v[156:159], v[104:107], v[88:91]
    s_waitcnt lgkmcnt(8)
    v_mfma_f32_16x16x32_bf16 v[8:11], v[136:139], v[120:123], v[8:11]
    ds_read_b64_tr_b16 v[156:157], v4 offset:8192
    v_mfma_f32_16x16x32_bf16 v[12:15], v[136:139], v[124:127], v[12:15]
    ds_read_b64_tr_b16 v[158:159], v4 offset:8704
    v_mfma_f32_16x16x32_bf16 v[16:19], v[136:139], v[128:131], v[16:19]
    s_barrier
    v_mfma_f32_16x16x32_bf16 v[20:23], v[136:139], v[132:135], v[20:23]
    s_waitcnt lgkmcnt(8)
    v_mfma_f32_16x16x32_bf16 v[36:39], v[140:143], v[132:135], v[36:39]
    ds_read_b128 v[104:107], v6 offset:0
    v_add_u32 v3, s60, v2
    v_mfma_f32_16x16x32_bf16 v[32:35], v[140:143], v[128:131], v[32:35]
    ds_read_b128 v[108:111], v6 offset:2048
    v_xor_b32 v4, 32, v3
    v_mfma_f32_16x16x32_bf16 v[28:31], v[140:143], v[124:127], v[28:31]
    ds_read_b128 v[112:115], v6 offset:4096
    v_mfma_f32_16x16x32_bf16 v[24:27], v[140:143], v[120:123], v[24:27]
    ds_read_b128 v[116:119], v6 offset:6144
    s_waitcnt lgkmcnt(10)
    v_mfma_f32_16x16x32_bf16 v[40:43], v[144:147], v[120:123], v[40:43]
    ds_read_b64_tr_b16 v[136:137], v3 offset:0
    s_add_u32 s60, s60, 12288
    v_mfma_f32_16x16x32_bf16 v[44:47], v[144:147], v[124:127], v[44:47]
    ds_read_b64_tr_b16 v[138:139], v3 offset:512
    s_cmp_eq_u32 s60, 159744
    v_mfma_f32_16x16x32_bf16 v[48:51], v[144:147], v[128:131], v[48:51]
    ds_read_b64_tr_b16 v[140:141], v4 offset:0
    s_cselect_b32 s60, 98304, s60
    v_mfma_f32_16x16x32_bf16 v[52:55], v[144:147], v[132:135], v[52:55]
    ds_read_b64_tr_b16 v[142:143], v4 offset:512
    s_waitcnt lgkmcnt(12)
    v_mfma_f32_16x16x32_bf16 v[68:71], v[148:151], v[132:135], v[68:71]
    ds_read_b64_tr_b16 v[144:145], v3 offset:4096
    s_add_u32 s61, s61, 16384
    v_mfma_f32_16x16x32_bf16 v[64:67], v[148:151], v[128:131], v[64:67]
    ds_read_b64_tr_b16 v[146:147], v3 offset:4608
    s_cmp_eq_u32 s61, 98304
    v_mfma_f32_16x16x32_bf16 v[60:63], v[148:151], v[124:127], v[60:63]
    s_cselect_b32 s61, 0, s61
    v_mfma_f32_16x16x32_bf16 v[56:59], v[148:151], v[120:123], v[56:59]
    s_waitcnt lgkmcnt(12)
    v_mfma_f32_16x16x32_bf16 v[72:75], v[152:155], v[120:123], v[72:75]
    ds_read_b64_tr_b16 v[148:149], v4 offset:4096
    v_mfma_f32_16x16x32_bf16 v[76:79], v[152:155], v[124:127], v[76:79]
    ds_read_b64_tr_b16 v[150:151], v4 offset:4608
    v_mfma_f32_16x16x32_bf16 v[80:83], v[152:155], v[128:131], v[80:83]
    v_mfma_f32_16x16x32_bf16 v[84:87], v[152:155], v[132:135], v[84:87]
    s_waitcnt lgkmcnt(12)
    v_mfma_f32_16x16x32_bf16 v[100:103], v[156:159], v[132:135], v[100:103]
    ds_read_b64_tr_b16 v[152:153], v3 offset:8192
    s_sub_u32 s62, s62, 1
    v_mfma_f32_16x16x32_bf16 v[96:99], v[156:159], v[128:131], v[96:99]
    ds_read_b64_tr_b16 v[154:155], v3 offset:8704
    s_cmp_lg_u32 s62, 0
    v_mfma_f32_16x16x32_bf16 v[92:95], v[156:159], v[124:127], v[92:95]
    v_mfma_f32_16x16x32_bf16 v[88:91], v[156:159], v[120:123], v[88:91]
    s_waitcnt lgkmcnt(8)
    s_cbranch_scc1 L1_aT
    s_barrier
    s_waitcnt lgkmcnt(0)
    s_branch L1_epi
L1_aN:
    v_mfma_f32_16x16x32_bf16 v[8:11], v[136:139], v[104:107], v[8:11]
    ds_read_b64_tr_b16 v[156:157], v4 offset:8192
    v_mfma_f32_16x16x32_bf16 v[12:15], v[136:139], v[108:111], v[12:15]
    ds_read_b64_tr_b16 v[158:159], v4 offset:8704
    v_mfma_f32_16x16x32_bf16 v[16:19], v[136:139], v[112:115], v[16:19]
    s_barrier
    v_mfma_f32_16x16x32_bf16 v[20:23], v[136:139], v[116:119], v[20:23]
    s_waitcnt lgkmcnt(8)
    v_mfma_f32_16x16x32_bf16 v[36:39], v[140:143], v[116:119], v[36:39]
    ds_read_b128 v[120:123], v7 offset:0
    v_add_u32 v3, s60, v2
    v_mfma_f32_16x16x32_bf16 v[32:35], v[140:143], v[112:115], v[32:35]
    ds_read_b128 v[124:127], v7 offset:2048
    v_xor_b32 v4, 32, v3
    v_mfma_f32_16x16x32_bf16 v[28:31], v[140:143], v[108:111], v[28:31]
    ds_read_b128 v[128:131], v7 offset:4096
    v_mfma_f32_16x16x32_bf16 v[24:27], v[140:143], v[104:107], v[24:27]
    ds_read_b128 v[132:135], v7 offset:6144
    s_waitcnt lgkmcnt(10)
    v_mfma_f32_16x16x32_bf16 v[40:43], v[144:147], v[104:107], v[40:43]
    ds_read_b64_tr_b16 v[136:137], v3 offset:0
    s_add_u32 s60, s60, 12288
    v_mfma_f32_16x16x32_bf16 v[44:47], v[144:147], v[108:111], v[44:47]
    ds_read_b64_tr_b16 v[138:139], v3 offset:512
    s_cmp_eq_u32 s60, 159744
    v_mfma_f32_16x16x32_bf16 v[48:51], v[144:147], v[112:115], v[48:51]
    ds_read_b64_tr_b16 v[140:141], v4 offset:0
    s_cselect_b32 s60, 98304, s60
    v_mfma_f32_16x16x32_bf16 v[52:55], v[144:147], v[116:119], v[52:55]
    ds_read_b64_tr_b16 v[142:143], v4 offset:512
    s_waitcnt lgkmcnt(12)
    v_mfma_f32_16x16x32_bf16 v[68:71], v[148:151], v[116:119], v[68:71]
    ds_read_b64_tr_b16 v[144:145], v3 offset:4096
    v_add_u32 v6, s61, v5
    v_mfma_f32_16x16x32_bf16 v[64:67], v[148:151], v[112:115], v[64:67]
    ds_read_b64_tr_b16 v[146:147], v3 offset:4608
    v_xor_b32 v7, 64, v6
    v_mfma_f32_16x16x32_bf16 v[60:63], v[148:151], v[108:111], v[60:63]
    v_mfma_f32_16x16x32_bf16 v[56:59], v[148:151], v[104:107], v[56:59]
    s_waitcnt lgkmcnt(12)
    v_mfma_f32_16x16x32_bf16 v[72:75], v[104:107], v[152:155], v[72:75]
    ds_read_b64_tr_b16 v[148:149], v4 offset:4096
    v_mfma_f32_16x16x32_bf16 v[76:79], v[108:111], v[152:155], v[76:79]
    ds_read_b64_tr_b16 v[150:151], v4 offset:4608
    v_mfma_f32_16x16x32_bf16 v[80:83], v[112:115], v[152:155], v[80:83]
    v_mfma_f32_16x16x32_bf16 v[84:87], v[116:119], v[152:155], v[84:87]
    s_waitcnt lgkmcnt(12)
    v_mfma_f32_16x16x32_bf16 v[100:103], v[116:119], v[156:159], v[100:103]
    ds_read_b64_tr_b16 v[152:153], v3 offset:8192
    v_mfma_f32_16x16x32_bf16 v[96:99], v[112:115], v[156:159], v[96:99]
    ds_read_b64_tr_b16 v[154:155], v3 offset:8704
    v_mfma_f32_16x16x32_bf16 v[92:95], v[108:111], v[156:159], v[92:95]
    v_mfma_f32_16x16x32_bf16 v[88:91], v[104:107], v[156:159], v[88:91]
    s_waitcnt lgkmcnt(8)
    v_mfma_f32_16x16x32_bf16 v[8:11], v[136:139], v[120:123], v[8:11]
    ds_read_b64_tr_b16 v[156:157], v4 offset:8192
    v_mfma_f32_16x16x32_bf16 v[12:15], v[136:139], v[124:127], v[12:15]
    ds_read_b64_tr_b16 v[158:159], v4 offset:8704
    v_mfma_f32_16x16x32_bf16 v[16:19], v[136:139], v[128:131], v[16:19]
    s_barrier
    v_mfma_f32_16x16x32_bf16 v[20:23], v[136:139], v[132:135], v[20:23]
    s_waitcnt lgkmcnt(8)
    v_mfma_f32_16x16x32_bf16 v[36:39], v[140:143], v[132:135], v[36:39]
    ds_read_b128 v[104:107], v6 offset:0
    v_add_u32 v3, s60, v2
    v_mfma_f32_16x16x32_bf16 v[32:35], v[140:143], v[128:131], v[32:35]
    ds_read_b128 v[108:111], v6 offset:2048
    v_xor_b32 v4, 32, v3
    v_mfma_f32_16x16x32_bf16 v[28:31], v[140:143], v[124:127], v[28:31]
    ds_read_b128 v[112:115], v6 offset:4096
    v_mfma_f32_16x16x32_bf16 v[24:27], v[140:143], v[120:123], v[24:27]
    ds_read_b128 v[116:119], v6 offset:6144
    s_waitcnt lgkmcnt(10)
    v_mfma_f32_16x16x32_bf16 v[40:43], v[144:147], v[120:123], v[40:43]
    ds_read_b64_tr_b16 v[136:137], v3 offset:0
    s_add_u32 s60, s60, 12288
    v_mfma_f32_16x16x32_bf16 v[44:47], v[144:147], v[124:127], v[44:47]
    ds_read_b64_tr_b16 v[138:139], v3 offset:512
    s_cmp_eq_u32 s60, 159744
    v_mfma_f32_16x16x32_bf16 v[48:51], v[144:147], v[128:131], v[48:51]
    ds_read_b64_tr_b16 v[140:141], v4 offset:0
    s_cselect_b32 s60, 98304, s60
    v_mfma_f32_16x16x32_bf16 v[52:55], v[144:147], v[132:135], v[52:55]
    ds_read_b64_tr_b16 v[142:143], v4 offset:512
    s_waitcnt lgkmcnt(12)
    v_mfma_f32_16x16x32_bf16 v[68:71], v[148:151], v[132:135], v[68:71]
    ds_read_b64_tr_b16 v[144:145], v3 offset:4096
    s_add_u32 s61, s61, 16384
    v_mfma_f32_16x16x32_bf16 v[64:67], v[148:151], v[128:131], v[64:67]
    ds_read_b64_tr_b16 v[146:147], v3 offset:4608
    s_cmp_eq_u32 s61, 98304
    v_mfma_f32_16x16x32_bf16 v[60:63], v[148:151], v[124:127], v[60:63]
    s_cselect_b32 s61, 0, s61
    v_mfma_f32_16x16x32_bf16 v[56:59], v[148:151], v[120:123], v[56:59]
    s_waitcnt lgkmcnt(12)
    v_mfma_f32_16x16x32_bf16 v[72:75], v[120:123], v[152:155], v[72:75]
    ds_read_b64_tr_b16 v[148:149], v4 offset:4096
    v_mfma_f32_16x16x32_bf16 v[76:79], v[124:127], v[152:155], v[76:79]
    ds_read_b64_tr_b16 v[150:151], v4 offset:4608
    v_mfma_f32_16x16x32_bf16 v[80:83], v[128:131], v[152:155], v[80:83]
    v_mfma_f32_16x16x32_bf16 v[84:87], v[132:135], v[152:155], v[84:87]
    s_waitcnt lgkmcnt(12)
    v_mfma_f32_16x16x32_bf16 v[100:103], v[132:135], v[156:159], v[100:103]
    ds_read_b64_tr_b16 v[152:153], v3 offset:8192
    v_mfma_f32_16x16x32_bf16 v[96:99], v[128:131], v[156:159], v[96:99]
    ds_read_b64_tr_b16 v[154:155], v3 offset:8704
    v_mfma_f32_16x16x32_bf16 v[92:95], v[124:127], v[156:159], v[92:95]
    v_mfma_f32_16x16x32_bf16 v[88:91], v[120:123], v[156:159], v[88:91]
    s_waitcnt lgkmcnt(8)
    v_mfma_f32_16x16x32_bf16 v[8:11], v[136:139], v[104:107], v[8:11]
    ds_read_b64_tr_b16 v[156:157], v4 offset:8192
    v_mfma_f32_16x16x32_bf16 v[12:15], v[136:139], v[108:111], v[12:15]
    ds_read_b64_tr_b16 v[158:159], v4 offset:8704
    v_mfma_f32_16x16x32_bf16 v[16:19], v[136:139], v[112:115], v[16:19]
    s_barrier
    v_mfma_f32_16x16x32_bf16 v[20:23], v[136:139], v[116:119], v[20:23]
    s_waitcnt lgkmcnt(8)
    v_mfma_f32_16x16x32_bf16 v[36:39], v[140:143], v[116:119], v[36:39]
    ds_read_b128 v[120:123], v7 offset:0
    v_add_u32 v3, s60, v2
    v_mfma_f32_16x16x32_bf16 v[32:35], v[140:143], v[112:115], v[32:35]
    ds_read_b128 v[124:127], v7 offset:2048
    v_xor_b32 v4, 32, v3
    v_mfma_f32_16x16x32_bf16 v[28:31], v[140:143], v[108:111], v[28:31]
    ds_read_b128 v[128:131], v7 offset:4096
    v_mfma_f32_16x16x32_bf16 v[24:27], v[140:143], v[104:107], v[24:27]
    ds_read_b128 v[132:135], v7 offset:6144
    s_waitcnt lgkmcnt(10)
    v_mfma_f32_16x16x32_bf16 v[40:43], v[144:147], v[104:107], v[40:43]
    ds_read_b64_tr_b16 v[136:137], v3 offset:0
    s_add_u32 s60, s60, 12288
    v_mfma_f32_16x16x32_bf16 v[44:47], v[144:147], v[108:111], v[44:47]
    ds_read_b64_tr_b16 v[138:139], v3 offset:512
    s_cmp_eq_u32 s60, 159744
    v_mfma_f32_16x16x32_bf16 v[48:51], v[144:147], v[112:115], v[48:51]
    ds_read_b64_tr_b16 v[140:141], v4 offset:0
    s_cselect_b32 s60, 98304, s60
    v_mfma_f32_16x16x32_bf16 v[52:55], v[144:147], v[116:119], v[52:55]
    ds_read_b64_tr_b16 v[142:143], v4 offset:512
    s_waitcnt lgkmcnt(12)
    v_mfma_f32_16x16x32_bf16 v[68:71], v[148:151], v[116:119], v[68:71]
    ds_read_b64_tr_b16 v[144:145], v3 offset:4096
    v_add_u32 v6, s61, v5
    v_mfma_f32_16x16x32_bf16 v[64:67], v[148:151], v[112:115], v[64:67]
    ds_read_b64_tr_b16 v[146:147], v3 offset:4608
    v_xor_b32 v7, 64, v6
    v_mfma_f32_16x16x32_bf16 v[60:63], v[148:151], v[108:111], v[60:63]
    v_mfma_f32_16x16x32_bf16 v[56:59], v[148:151], v[104:107], v[56:59]
    s_waitcnt lgkmcnt(12)
    v_mfma_f32_16x16x32_bf16 v[72:75], v[104:107], v[152:155], v[72:75]
    ds_read_b64_tr_b16 v[148:149], v4 offset:4096
    v_mfma_f32_16x16x32_bf16 v[76:79], v[108:111], v[152:155], v[76:79]
    ds_read_b64_tr_b16 v[150:151], v4 offset:4608
    v_mfma_f32_16x16x32_bf16 v[80:83], v[112:115], v[152:155], v[80:83]
    v_mfma_f32_16x16x32_bf16 v[84:87], v[116:119], v[152:155], v[84:87]
    s_waitcnt lgkmcnt(12)
    v_mfma_f32_16x16x32_bf16 v[100:103], v[116:119], v[156:159], v[100:103]
    ds_read_b64_tr_b16 v[152:153], v3 offset:8192
    v_mfma_f32_16x16x32_bf16 v[96:99], v[112:115], v[156:159], v[96:99]
    ds_read_b64_tr_b16 v[154:155], v3 offset:8704
    v_mfma_f32_16x16x32_bf16 v[92:95], v[108:111], v[156:159], v[92:95]
    v_mfma_f32_16x16x32_bf16 v[88:91], v[104:107], v[156:159], v[88:91]
    s_waitcnt lgkmcnt(8)
    v_mfma_f32_16x16x32_bf16 v[8:11], v[136:139], v[120:123], v[8:11]
    ds_read_b64_tr_b16 v[156:157], v4 offset:8192
    v_mfma_f32_16x16x32_bf16 v[12:15], v[136:139], v[124:127], v[12:15]
    ds_read_b64_tr_b16 v[158:159], v4 offset:8704
    v_mfma_f32_16x16x32_bf16 v[16:19], v[136:139], v[128:131], v[16:19]
    s_barrier
    v_mfma_f32_16x16x32_bf16 v[20:23], v[136:139], v[132:135], v[20:23]
    s_waitcnt lgkmcnt(8)
    v_mfma_f32_16x16x32_bf16 v[36:39], v[140:143], v[132:135], v[36:39]
    ds_read_b128 v[104:107], v6 offset:0
    v_add_u32 v3, s60, v2
    v_mfma_f32_16x16x32_bf16 v[32:35], v[140:143], v[128:131], v[32:35]
    ds_read_b128 v[108:111], v6 offset:2048
    v_xor_b32 v4, 32, v3
    v_mfma_f32_16x16x32_bf16 v[28:31], v[140:143], v[124:127], v[28:31]
    ds_read_b128 v[112:115], v6 offset:4096
    v_mfma_f32_16x16x32_bf16 v[24:27], v[140:143], v[120:123], v[24:27]
    ds_read_b128 v[116:119], v6 offset:6144
    s_waitcnt lgkmcnt(10)
    v_mfma_f32_16x16x32_bf16 v[40:43], v[144:147], v[120:123], v[40:43]
    ds_read_b64_tr_b16 v[136:137], v3 offset:0
    s_add_u32 s60, s60, 12288
    v_mfma_f32_16x16x32_bf16 v[44:47], v[144:147], v[124:127], v[44:47]
    ds_read_b64_tr_b16 v[138:139], v3 offset:512
    s_cmp_eq_u32 s60, 159744
    v_mfma_f32_16x16x32_bf16 v[48:51], v[144:147], v[128:131], v[48:51]
    ds_read_b64_tr_b16 v[140:141], v4 offset:0
    s_cselect_b32 s60, 98304, s60
    v_mfma_f32_16x16x32_bf16 v[52:55], v[144:147], v[132:135], v[52:55]
    ds_read_b64_tr_b16 v[142:143], v4 offset:512
    s_waitcnt lgkmcnt(12)
    v_mfma_f32_16x16x32_bf16 v[68:71], v[148:151], v[132:135], v[68:71]
    ds_read_b64_tr_b16 v[144:145], v3 offset:4096
    s_add_u32 s61, s61, 16384
    v_mfma_f32_16x16x32_bf16 v[64:67], v[148:151], v[128:131], v[64:67]
    ds_read_b64_tr_b16 v[146:147], v3 offset:4608
    s_cmp_eq_u32 s61, 98304
    v_mfma_f32_16x16x32_bf16 v[60:63], v[148:151], v[124:127], v[60:63]
    s_cselect_b32 s61, 0, s61
    v_mfma_f32_16x16x32_bf16 v[56:59], v[148:151], v[120:123], v[56:59]
    s_waitcnt lgkmcnt(12)
    v_mfma_f32_16x16x32_bf16 v[72:75], v[120:123], v[152:155], v[72:75]
    ds_read_b64_tr_b16 v[148:149], v4 offset:4096
    v_mfma_f32_16x16x32_bf16 v[76:79], v[124:127], v[152:155], v[76:79]
    ds_read_b64_tr_b16 v[150:151], v4 offset:4608
    v_mfma_f32_16x16x32_bf16 v[80:83], v[128:131], v[152:155], v[80:83]
    v_mfma_f32_16x16x32_bf16 v[84:87], v[132:135], v[152:155], v[84:87]
    s_waitcnt lgkmcnt(12)
    v_mfma_f32_16x16x32_bf16 v[100:103], v[132:135], v[156:159], v[100:103]
    ds_read_b64_tr_b16 v[152:153], v3 offset:8192
    s_sub_u32 s62, s62, 1
    v_mfma_f32_16x16x32_bf16 v[96:99], v[128:131], v[156:159], v[96:99]
    ds_read_b64_tr_b16 v[154:155], v3 offset:8704
    s_cmp_lg_u32 s62, 0
    v_mfma_f32_16x16x32_bf16 v[92:95], v[124:127], v[156:159], v[92:95]
    v_mfma_f32_16x16x32_bf16 v[88:91], v[120:123], v[156:159], v[88:91]
    s_waitcnt lgkmcnt(8)
    s_cbranch_scc1 L1_aN
    s_barrier
    s_waitcnt lgkmcnt(0)
L1_epi:
    s_setprio 0
    ds_read_b32 v1, v1 offset:8
    ds_read_b64 v[104:105], v162 offset:0
    ds_read_b64 v[106:107], v162 offset:128
    ds_read_b64 v[108:109], v162 offset:256
    ds_read_b64 v[110:111], v162 offset:384
    ds_read_b128 v[112:115], v164 offset:512
    ds_read_b128 v[116:119], v164 offset:576
    ds_read_b128 v[120:123], v164 offset:768
    ds_read_b128 v[124:127], v164 offset:832
    v_lshlrev_b32 v2, 4, v0
    s_waitcnt vmcnt(0)
    s_cmp_lt_u32 s57, 20
    s_cbranch_scc0 L1_v
    ds_read_b128 v[128:131], v164 offset:1024
    ds_read_b128 v[132:135], v164 offset:1088
    s_mul_i32 s64, s63, 160
    s_lshl_b32 s10, s57, 3
    s_add_u32 s64, s64, s10
    s_lshl_b32 s10, s58, 2
    s_add_u32 s64, s64, s10
    s_lshl_b32 s64, s64, 9
    s_add_u32 s64, s64, 2621440
    s_add_u32 s65, s64, 81920
    s_cmp_lt_u32 s57, 10
    s_cselect_b32 s66, 0x3ea52b5c, 1.0
    s_waitcnt lgkmcnt(0)
    v_mul_f32 v136, s66, v105
    v_mul_f32 v137, s66, v107
    v_mul_f32 v138, s66, v109
    v_mul_f32 v139, s66, v111
    v_fmac_f32 v72, v128, v104
    v_fmac_f32 v73, v129, v104
    v_fmac_f32 v74, v130, v104
    v_fmac_f32 v75, v131, v104
    v_fmac_f32 v76, v128, v106
    v_fmac_f32 v77, v129, v106
    v_fmac_f32 v78, v130, v106
    v_fmac_f32 v79, v131, v106
    v_fmac_f32 v80, v128, v108
    v_fmac_f32 v81, v129, v108
    v_fmac_f32 v82, v130, v108
    v_fmac_f32 v83, v131, v108
    v_fmac_f32 v84, v128, v110
    v_fmac_f32 v85, v129, v110
    v_fmac_f32 v86, v130, v110
    v_fmac_f32 v87, v131, v110
    v_mul_f32 v72, v72, v136
    v_mul_f32 v73, v73, v136
    s_barrier
    v_mul_f32 v74, v74, v136
    v_mul_f32 v75, v75, v136
    v_mul_f32 v76, v76, v137
    v_mul_f32 v77, v77, v137
    v_mul_f32 v78, v78, v137
    v_mul_f32 v79, v79, v137
    v_mul_f32 v80, v80, v138
    v_mul_f32 v81, v81, v138
    v_mul_f32 v82, v82, v138
    v_mul_f32 v83, v83, v138
    v_mul_f32 v84, v84, v139
    v_mul_f32 v85, v85, v139
    v_mul_f32 v86, v86, v139
    v_mul_f32 v87, v87, v139
    v_cvt_pk_bf16_f32 v72, v72, v73
    v_cvt_pk_bf16_f32 v73, v74, v75
    v_cvt_pk_bf16_f32 v74, v76, v77
    v_cvt_pk_bf16_f32 v75, v78, v79
    v_cvt_pk_bf16_f32 v76, v80, v81
    v_cvt_pk_bf16_f32 v77, v82, v83
    v_cvt_pk_bf16_f32 v78, v84, v85
    v_cvt_pk_bf16_f32 v79, v86, v87
    s_nop 0
    v_permlane16_swap_b32 v72, v74
    v_permlane16_swap_b32 v73, v75
    v_permlane16_swap_b32 v76, v78
    v_permlane16_swap_b32 v77, v79
    buffer_store_dwordx4 v[72:75], v2, s[24:27], s64 offen offset:0 sc1
    buffer_store_dwordx4 v[76:79], v2, s[24:27], s65 offen offset:0 sc1
    v_fmac_f32 v88, v132, v104
    v_fmac_f32 v89, v133, v104
    v_fmac_f32 v90, v134, v104
    v_fmac_f32 v91, v135, v104
    v_fmac_f32 v92, v132, v106
    v_fmac_f32 v93, v133, v106
    v_fmac_f32 v94, v134, v106
    v_fmac_f32 v95, v135, v106
    v_fmac_f32 v96, v132, v108
    s_barrier
    v_fmac_f32 v97, v133, v108
    v_fmac_f32 v98, v134, v108
    v_fmac_f32 v99, v135, v108
    v_fmac_f32 v100, v132, v110
    v_fmac_f32 v101, v133, v110
    v_fmac_f32 v102, v134, v110
    v_fmac_f32 v103, v135, v110
    v_mul_f32 v88, v88, v136
    v_mul_f32 v89, v89, v136
    v_mul_f32 v90, v90, v136
    v_mul_f32 v91, v91, v136
    v_mul_f32 v92, v92, v137
    v_mul_f32 v93, v93, v137
    v_mul_f32 v94, v94, v137
    v_mul_f32 v95, v95, v137
    v_mul_f32 v96, v96, v138
    v_mul_f32 v97, v97, v138
    v_mul_f32 v98, v98, v138
    v_mul_f32 v99, v99, v138
    v_mul_f32 v100, v100, v139
    v_mul_f32 v101, v101, v139
    v_mul_f32 v102, v102, v139
    v_mul_f32 v103, v103, v139
    v_cvt_pk_bf16_f32 v88, v88, v89
    v_cvt_pk_bf16_f32 v89, v90, v91
    v_cvt_pk_bf16_f32 v90, v92, v93
    v_cvt_pk_bf16_f32 v91, v94, v95
    v_cvt_pk_bf16_f32 v92, v96, v97
    v_cvt_pk_bf16_f32 v93, v98, v99
    v_cvt_pk_bf16_f32 v94, v100, v101
    v_cvt_pk_bf16_f32 v95, v102, v103
    s_nop 0
    v_permlane16_swap_b32 v88, v90
    v_permlane16_swap_b32 v89, v91
    v_permlane16_swap_b32 v92, v94
    v_permlane16_swap_b32 v93, v95
    buffer_store_dwordx4 v[88:91], v2, s[24:27], s64 offen offset:1024 sc1
    buffer_store_dwordx4 v[92:95], v2, s[24:27], s65 offen offset:1024 sc1
    s_barrier
    s_branch L1_e2
L1_v:
    ds_read_b32 v160, v165 offset:1024
    ds_read_b32 v161, v165 offset:1088
    ds_read_b128 v[128:131], v163 offset:0
    ds_read_b128 v[132:135], v163 offset:16
    ds_read_b128 v[136:139], v163 offset:128
    ds_read_b128 v[140:143], v163 offset:144
    s_waitcnt lgkmcnt(6)
    ds_read_b128 v[144:147], v163 offset:256
    ds_read_b128 v[148:151], v163 offset:272
    ds_read_b128 v[152:155], v163 offset:384
    ds_read_b128 v[156:159], v163 offset:400
    s_lshl_b32 s10, s57, 1
    s_add_u32 s10, s10, s58
    s_lshl_b32 s10, s10, 7
    s_add_u32 s10, s10, s63
    s_lshl_b32 s64, s10, 10
    s_add_u32 s64, s64, 2621440
    s_add_u32 s65, s64, 1024
    s_waitcnt lgkmcnt(0)
    v_fmac_f32 v72, v128, v160
    v_fmac_f32 v73, v130, v160
    v_fmac_f32 v74, v132, v160
    v_fmac_f32 v75, v134, v160
    v_fmac_f32 v76, v136, v160
    v_fmac_f32 v77, v138, v160
    v_fmac_f32 v78, v140, v160
    v_fmac_f32 v79, v142, v160
    v_fmac_f32 v80, v144, v160
    v_fmac_f32 v81, v146, v160
    v_fmac_f32 v82, v148, v160
    v_fmac_f32 v83, v150, v160
    v_fmac_f32 v84, v152, v160
    v_fmac_f32 v85, v154, v160
    v_fmac_f32 v86, v156, v160
    v_fmac_f32 v87, v158, v160
    v_mul_f32 v72, v72, v129
    v_mul_f32 v73, v73, v131
    v_mul_f32 v74, v74, v133
    v_mul_f32 v75, v75, v135
    v_mul_f32 v76, v76, v137
    s_barrier
    v_mul_f32 v77, v77, v139
    v_mul_f32 v78, v78, v141
    v_mul_f32 v79, v79, v143
    v_mul_f32 v80, v80, v145
    v_mul_f32 v81, v81, v147
    v_mul_f32 v82, v82, v149
    v_mul_f32 v83, v83, v151
    v_mul_f32 v84, v84, v153
    v_mul_f32 v85, v85, v155
    v_mul_f32 v86, v86, v157
    v_mul_f32 v87, v87, v159
    v_cvt_pk_bf16_f32 v72, v72, v73
    v_cvt_pk_bf16_f32 v73, v74, v75
    v_cvt_pk_bf16_f32 v74, v76, v77
    v_cvt_pk_bf16_f32 v75, v78, v79
    v_cvt_pk_bf16_f32 v76, v80, v81
    v_cvt_pk_bf16_f32 v77, v82, v83
    v_cvt_pk_bf16_f32 v78, v84, v85
    v_cvt_pk_bf16_f32 v79, v86, v87
    s_nop 0
    v_permlane16_swap_b32 v72, v74
    v_permlane16_swap_b32 v73, v75
    v_permlane16_swap_b32 v76, v78
    v_permlane16_swap_b32 v77, v79
    buffer_store_dwordx4 v[72:75], v2, s[24:27], s64 offen offset:0 sc1
    buffer_store_dwordx4 v[76:79], v2, s[24:27], s65 offen offset:0 sc1
    s_add_u32 s64, s64, 65536
    s_add_u32 s65, s65, 65536
    v_fmac_f32 v88, v128, v161
    v_fmac_f32 v89, v130, v161
    v_fmac_f32 v90, v132, v161
    v_fmac_f32 v91, v134, v161
    v_fmac_f32 v92, v136, v161
    v_fmac_f32 v93, v138, v161
    v_fmac_f32 v94, v140, v161
    v_fmac_f32 v95, v142, v161
    v_fmac_f32 v96, v144, v161
    v_fmac_f32 v97, v146, v161
    s_barrier
    v_fmac_f32 v98, v148, v161
    v_fmac_f32 v99, v150, v161
    v_fmac_f32 v100, v152, v161
    v_fmac_f32 v101, v154, v161
    v_fmac_f32 v102, v156, v161
    v_fmac_f32 v103, v158, v161
    v_mul_f32 v88, v88, v129
    v_mul_f32 v89, v89, v131
    v_mul_f32 v90, v90, v133
    v_mul_f32 v91, v91, v135
    v_mul_f32 v92, v92, v137
    v_mul_f32 v93, v93, v139
    v_mul_f32 v94, v94, v141
    v_mul_f32 v95, v95, v143
    v_mul_f32 v96, v96, v145
    v_mul_f32 v97, v97, v147
    v_mul_f32 v98, v98, v149
    v_mul_f32 v99, v99, v151
    v_mul_f32 v100, v100, v153
    v_mul_f32 v101, v101, v155
    v_mul_f32 v102, v102, v157
    v_mul_f32 v103, v103, v159
    v_cvt_pk_bf16_f32 v88, v88, v89
    v_cvt_pk_bf16_f32 v89, v90, v91
    v_cvt_pk_bf16_f32 v90, v92, v93
    v_cvt_pk_bf16_f32 v91, v94, v95
    v_cvt_pk_bf16_f32 v92, v96, v97
    v_cvt_pk_bf16_f32 v93, v98, v99
    v_cvt_pk_bf16_f32 v94, v100, v101
    v_cvt_pk_bf16_f32 v95, v102, v103
    s_nop 0
    v_permlane16_swap_b32 v88, v90
    v_permlane16_swap_b32 v89, v91
    v_permlane16_swap_b32 v92, v94
    v_permlane16_swap_b32 v93, v95
    buffer_store_dwordx4 v[88:91], v2, s[24:27], s64 offen offset:0 sc1
    buffer_store_dwordx4 v[92:95], v2, s[24:27], s65 offen offset:0 sc1
    s_barrier
L1_e2:
    s_cmp_lt_u32 s53, 8
    s_cbranch_scc1 L1_fa
    s_cmp_ge_u32 s53, 14
    s_cbranch_scc0 L1_q2
    s_mul_i32 s64, s63, 160
    s_lshl_b32 s10, s55, 3
    s_add_u32 s64, s64, s10
    s_lshl_b32 s10, s58, 2
    s_add_u32 s64, s64, s10
    s_lshl_b32 s64, s64, 9
    s_add_u32 s64, s64, 2621440
    s_add_u32 s65, s64, 81920
    s_cmp_lt_u32 s55, 10
    s_cselect_b32 s66, 0x3ea52b5c, 1.0
    v_mul_f32 v136, s66, v105
    v_mul_f32 v137, s66, v107
    v_mul_f32 v138, s66, v109
    v_mul_f32 v139, s66, v111
    v_fmac_f32 v8, v112, v104
    v_fmac_f32 v9, v113, v104
    v_fmac_f32 v10, v114, v104
    v_fmac_f32 v11, v115, v104
    v_fmac_f32 v12, v112, v106
    v_fmac_f32 v13, v113, v106
    v_fmac_f32 v14, v114, v106
    v_fmac_f32 v15, v115, v106
    v_fmac_f32 v16, v112, v108
    v_fmac_f32 v17, v113, v108
    v_fmac_f32 v18, v114, v108
    v_fmac_f32 v19, v115, v108
    v_fmac_f32 v20, v112, v110
    v_fmac_f32 v21, v113, v110
    v_fmac_f32 v22, v114, v110
    v_fmac_f32 v23, v115, v110
    v_mul_f32 v8, v8, v136
    v_mul_f32 v9, v9, v136
    v_mul_f32 v10, v10, v136
    v_mul_f32 v11, v11, v136
    v_mul_f32 v12, v12, v137
    v_mul_f32 v13, v13, v137
    v_mul_f32 v14, v14, v137
    v_mul_f32 v15, v15, v137
    v_mul_f32 v16, v16, v138
    s_barrier
    v_mul_f32 v17, v17, v138
    v_mul_f32 v18, v18, v138
    v_mul_f32 v19, v19, v138
    v_mul_f32 v20, v20, v139
    v_mul_f32 v21, v21, v139
    v_mul_f32 v22, v22, v139
    v_mul_f32 v23, v23, v139
    v_cvt_pk_bf16_f32 v8, v8, v9
    v_cvt_pk_bf16_f32 v9, v10, v11
    v_cvt_pk_bf16_f32 v10, v12, v13
    v_cvt_pk_bf16_f32 v11, v14, v15
    v_cvt_pk_bf16_f32 v12, v16, v17
    v_cvt_pk_bf16_f32 v13, v18, v19
    v_cvt_pk_bf16_f32 v14, v20, v21
    v_cvt_pk_bf16_f32 v15, v22, v23
    s_nop 0
    v_permlane16_swap_b32 v8, v10
    v_permlane16_swap_b32 v9, v11
    v_permlane16_swap_b32 v12, v14
    v_permlane16_swap_b32 v13, v15
    buffer_store_dwordx4 v[8:11], v2, s[24:27], s64 offen offset:0 sc1
    buffer_store_dwordx4 v[12:15], v2, s[24:27], s65 offen offset:0 sc1
    v_fmac_f32 v24, v116, v104
    v_fmac_f32 v25, v117, v104
    v_fmac_f32 v26, v118, v104
    v_fmac_f32 v27, v119, v104
    v_fmac_f32 v28, v116, v106
    v_fmac_f32 v29, v117, v106
    v_fmac_f32 v30, v118, v106
    v_fmac_f32 v31, v119, v106
    v_fmac_f32 v32, v116, v108
    v_fmac_f32 v33, v117, v108
    v_fmac_f32 v34, v118, v108
    v_fmac_f32 v35, v119, v108
    v_fmac_f32 v36, v116, v110
    s_barrier
    v_fmac_f32 v37, v117, v110
    v_fmac_f32 v38, v118, v110
    v_fmac_f32 v39, v119, v110
    v_mul_f32 v24, v24, v136
    v_mul_f32 v25, v25, v136
    v_mul_f32 v26, v26, v136
    v_mul_f32 v27, v27, v136
    v_mul_f32 v28, v28, v137
    v_mul_f32 v29, v29, v137
    v_mul_f32 v30, v30, v137
    v_mul_f32 v31, v31, v137
    v_mul_f32 v32, v32, v138
    v_mul_f32 v33, v33, v138
    v_mul_f32 v34, v34, v138
    v_mul_f32 v35, v35, v138
    v_mul_f32 v36, v36, v139
    v_mul_f32 v37, v37, v139
    v_mul_f32 v38, v38, v139
    v_mul_f32 v39, v39, v139
    v_cvt_pk_bf16_f32 v24, v24, v25
    v_cvt_pk_bf16_f32 v25, v26, v27
    v_cvt_pk_bf16_f32 v26, v28, v29
    v_cvt_pk_bf16_f32 v27, v30, v31
    v_cvt_pk_bf16_f32 v28, v32, v33
    v_cvt_pk_bf16_f32 v29, v34, v35
    v_cvt_pk_bf16_f32 v30, v36, v37
    v_cvt_pk_bf16_f32 v31, v38, v39
    s_nop 0
    v_permlane16_swap_b32 v24, v26
    v_permlane16_swap_b32 v25, v27
    v_permlane16_swap_b32 v28, v30
    v_permlane16_swap_b32 v29, v31
    buffer_store_dwordx4 v[24:27], v2, s[24:27], s64 offen offset:1024 sc1
    buffer_store_dwordx4 v[28:31], v2, s[24:27], s65 offen offset:1024 sc1
    s_barrier
    s_barrier
    s_barrier
    s_branch L1_q3
L1_q2:
    s_mul_i32 s64, s63, 160
    s_lshl_b32 s10, s55, 3
    s_add_u32 s64, s64, s10
    s_lshl_b32 s10, s58, 2
    s_add_u32 s64, s64, s10
    s_lshl_b32 s64, s64, 9
    s_add_u32 s64, s64, 2621440
    s_add_u32 s65, s64, 81920
    s_cmp_lt_u32 s55, 10
    s_cselect_b32 s66, 0x3ea52b5c, 1.0
    v_mul_f32 v136, s66, v105
    v_mul_f32 v137, s66, v107
    v_mul_f32 v138, s66, v109
    v_mul_f32 v139, s66, v111
    v_fmac_f32 v8, v112, v104
    v_fmac_f32 v9, v113, v104
    v_fmac_f32 v10, v114, v104
    v_fmac_f32 v11, v115, v104
    v_fmac_f32 v12, v112, v106
    v_fmac_f32 v13, v113, v106
    v_fmac_f32 v14, v114, v106
    v_fmac_f32 v15, v115, v106
    v_fmac_f32 v16, v112, v108
    v_fmac_f32 v17, v113, v108
    v_fmac_f32 v18, v114, v108
    v_fmac_f32 v19, v115, v108
    v_fmac_f32 v20, v112, v110
    v_fmac_f32 v21, v113, v110
    v_fmac_f32 v22, v114, v110
    v_fmac_f32 v23, v115, v110
    v_mul_f32 v8, v8, v136
    v_mul_f32 v9, v9, v136
    v_mul_f32 v10, v10, v136
    v_mul_f32 v11, v11, v136
    v_mul_f32 v12, v12, v137
    v_mul_f32 v13, v13, v137
    v_mul_f32 v14, v14, v137
    v_mul_f32 v15, v15, v137
    v_mul_f32 v16, v16, v138
    v_mul_f32 v17, v17, v138
    v_mul_f32 v18, v18, v138
    v_mul_f32 v19, v19, v138
    v_mul_f32 v20, v20, v139
    v_mul_f32 v21, v21, v139
    v_mul_f32 v22, v22, v139
    v_mul_f32 v23, v23, v139
    s_barrier
    v_cvt_pk_bf16_f32 v8, v8, v9
    v_cvt_pk_bf16_f32 v9, v10, v11
    v_cvt_pk_bf16_f32 v10, v12, v13
    v_cvt_pk_bf16_f32 v11, v14, v15
    v_cvt_pk_bf16_f32 v12, v16, v17
    v_cvt_pk_bf16_f32 v13, v18, v19
    v_cvt_pk_bf16_f32 v14, v20, v21
    v_cvt_pk_bf16_f32 v15, v22, v23
    s_nop 0
    v_permlane16_swap_b32 v8, v10
    v_permlane16_swap_b32 v9, v11
    v_permlane16_swap_b32 v12, v14
    v_permlane16_swap_b32 v13, v15
    buffer_store_dwordx4 v[8:11], v2, s[24:27], s64 offen offset:0 sc1
    buffer_store_dwordx4 v[12:15], v2, s[24:27], s65 offen offset:0 sc1
    v_fmac_f32 v24, v116, v104
    v_fmac_f32 v25, v117, v104
    v_fmac_f32 v26, v118, v104
    v_fmac_f32 v27, v119, v104
    v_fmac_f32 v28, v116, v106
    v_fmac_f32 v29, v117, v106
    v_fmac_f32 v30, v118, v106
    v_fmac_f32 v31, v119, v106
    v_fmac_f32 v32, v116, v108
    v_fmac_f32 v33, v117, v108
    v_fmac_f32 v34, v118, v108
    v_fmac_f32 v35, v119, v108
    v_fmac_f32 v36, v116, v110
    v_fmac_f32 v37, v117, v110
    v_fmac_f32 v38, v118, v110
    v_fmac_f32 v39, v119, v110
    v_mul_f32 v24, v24, v136
    v_mul_f32 v25, v25, v136
    v_mul_f32 v26, v26, v136
    v_mul_f32 v27, v27, v136
    v_mul_f32 v28, v28, v137
    v_mul_f32 v29, v29, v137
    v_mul_f32 v30, v30, v137
    v_mul_f32 v31, v31, v137
    v_mul_f32 v32, v32, v138
    v_mul_f32 v33, v33, v138
    v_mul_f32 v34, v34, v138
    s_barrier
    v_mul_f32 v35, v35, v138
    v_mul_f32 v36, v36, v139
    v_mul_f32 v37, v37, v139
    v_mul_f32 v38, v38, v139
    v_mul_f32 v39, v39, v139
    v_cvt_pk_bf16_f32 v24, v24, v25
    v_cvt_pk_bf16_f32 v25, v26, v27
    v_cvt_pk_bf16_f32 v26, v28, v29
    v_cvt_pk_bf16_f32 v27, v30, v31
    v_cvt_pk_bf16_f32 v28, v32, v33
    v_cvt_pk_bf16_f32 v29, v34, v35
    v_cvt_pk_bf16_f32 v30, v36, v37
    v_cvt_pk_bf16_f32 v31, v38, v39
    s_nop 0
    v_permlane16_swap_b32 v24, v26
    v_permlane16_swap_b32 v25, v27
    v_permlane16_swap_b32 v28, v30
    v_permlane16_swap_b32 v29, v31
    buffer_store_dwordx4 v[24:27], v2, s[24:27], s64 offen offset:1024 sc1
    buffer_store_dwordx4 v[28:31], v2, s[24:27], s65 offen offset:1024 sc1
    s_mul_i32 s64, s63, 160
    s_lshl_b32 s10, s56, 3
    s_add_u32 s64, s64, s10
    s_lshl_b32 s10, s58, 2
    s_add_u32 s64, s64, s10
    s_lshl_b32 s64, s64, 9
    s_add_u32 s64, s64, 2621440
    s_add_u32 s65, s64, 81920
    s_cmp_lt_u32 s56, 10
    s_cselect_b32 s66, 0x3ea52b5c, 1.0
    v_mul_f32 v136, s66, v105
    v_mul_f32 v137, s66, v107
    v_mul_f32 v138, s66, v109
    v_mul_f32 v139, s66, v111
    v_fmac_f32 v40, v120, v104
    v_fmac_f32 v41, v121, v104
    v_fmac_f32 v42, v122, v104
    v_fmac_f32 v43, v123, v104
    v_fmac_f32 v44, v120, v106
    v_fmac_f32 v45, v121, v106
    v_fmac_f32 v46, v122, v106
    v_fmac_f32 v47, v123, v106
    v_fmac_f32 v48, v120, v108
    v_fmac_f32 v49, v121, v108
    v_fmac_f32 v50, v122, v108
    v_fmac_f32 v51, v123, v108
    s_barrier
    v_fmac_f32 v52, v120, v110
    v_fmac_f32 v53, v121, v110
    v_fmac_f32 v54, v122, v110
    v_fmac_f32 v55, v123, v110
    v_mul_f32 v40, v40, v136
    v_mul_f32 v41, v41, v136
    v_mul_f32 v42, v42, v136
    v_mul_f32 v43, v43, v136
    v_mul_f32 v44, v44, v137
    v_mul_f32 v45, v45, v137
    v_mul_f32 v46, v46, v137
    v_mul_f32 v47, v47, v137
    v_mul_f32 v48, v48, v138
    v_mul_f32 v49, v49, v138
    v_mul_f32 v50, v50, v138
    v_mul_f32 v51, v51, v138
    v_mul_f32 v52, v52, v139
    v_mul_f32 v53, v53, v139
    v_mul_f32 v54, v54, v139
    v_mul_f32 v55, v55, v139
    v_cvt_pk_bf16_f32 v40, v40, v41
    v_cvt_pk_bf16_f32 v41, v42, v43
    v_cvt_pk_bf16_f32 v42, v44, v45
    v_cvt_pk_bf16_f32 v43, v46, v47
    v_cvt_pk_bf16_f32 v44, v48, v49
    v_cvt_pk_bf16_f32 v45, v50, v51
    v_cvt_pk_bf16_f32 v46, v52, v53
    v_cvt_pk_bf16_f32 v47, v54, v55
    s_nop 0
    v_permlane16_swap_b32 v40, v42
    v_permlane16_swap_b32 v41, v43
    v_permlane16_swap_b32 v44, v46
    v_permlane16_swap_b32 v45, v47
    buffer_store_dwordx4 v[40:43], v2, s[24:27], s64 offen offset:0 sc1
    buffer_store_dwordx4 v[44:47], v2, s[24:27], s65 offen offset:0 sc1
    v_fmac_f32 v56, v124, v104
    v_fmac_f32 v57, v125, v104
    v_fmac_f32 v58, v126, v104
    v_fmac_f32 v59, v127, v104
    v_fmac_f32 v60, v124, v106
    v_fmac_f32 v61, v125, v106
    s_barrier
    v_fmac_f32 v62, v126, v106
    v_fmac_f32 v63, v127, v106
    v_fmac_f32 v64, v124, v108
    v_fmac_f32 v65, v125, v108
    v_fmac_f32 v66, v126, v108
    v_fmac_f32 v67, v127, v108
    v_fmac_f32 v68, v124, v110
    v_fmac_f32 v69, v125, v110
    v_fmac_f32 v70, v126, v110
    v_fmac_f32 v71, v127, v110
    v_mul_f32 v56, v56, v136
    v_mul_f32 v57, v57, v136
    v_mul_f32 v58, v58, v136
    v_mul_f32 v59, v59, v136
    v_mul_f32 v60, v60, v137
    v_mul_f32 v61, v61, v137
    v_mul_f32 v62, v62, v137
    v_mul_f32 v63, v63, v137
    v_mul_f32 v64, v64, v138
    v_mul_f32 v65, v65, v138
    v_mul_f32 v66, v66, v138
    v_mul_f32 v67, v67, v138
    v_mul_f32 v68, v68, v139
    v_mul_f32 v69, v69, v139
    v_mul_f32 v70, v70, v139
    v_mul_f32 v71, v71, v139
    v_cvt_pk_bf16_f32 v56, v56, v57
    v_cvt_pk_bf16_f32 v57, v58, v59
    v_cvt_pk_bf16_f32 v58, v60, v61
    v_cvt_pk_bf16_f32 v59, v62, v63
    v_cvt_pk_bf16_f32 v60, v64, v65
    v_cvt_pk_bf16_f32 v61, v66, v67
    v_cvt_pk_bf16_f32 v62, v68, v69
    v_cvt_pk_bf16_f32 v63, v70, v71
    s_nop 0
    v_permlane16_swap_b32 v56, v58
    v_permlane16_swap_b32 v57, v59
    v_permlane16_swap_b32 v60, v62
    v_permlane16_swap_b32 v61, v63
    buffer_store_dwordx4 v[56:59], v2, s[24:27], s64 offen offset:1024 sc1
    buffer_store_dwordx4 v[60:63], v2, s[24:27], s65 offen offset:1024 sc1
    s_barrier
L1_q3:
    s_barrier
    s_barrier
    s_waitcnt vmcnt(0)
    s_barrier
    s_cmp_lg_u32 s3, 0
    s_cbranch_scc1 L1_sgb
    v_lshlrev_b32 v3, 2, v0
    s_mov_b32 exec_hi, 0
    buffer_store_dword v1, v3, s[24:27], s67 offen sc1
    s_mov_b64 exec, -1
L1_sgb:
    s_barrier
    s_barrier
    s_barrier
    s_barrier
    s_barrier
    s_barrier
    s_branch L1_join
L1_fa:
    s_mul_i32 s68, s63, 192
    s_lshl_b32 s10, s55, 3
    s_add_u32 s68, s68, s10
    s_lshl_b32 s10, s58, 2
    s_add_u32 s68, s68, s10
    s_lshl_b32 s68, s68, 9
    s_add_u32 s68, s68, 10485760
    s_add_u32 s69, s68, 1024
    v_mul_f32 v144, v105, v105
    v_mul_f32 v140, 0xbfb8aa3b, v105
    v_mul_f32 v145, v107, v107
    v_mul_f32 v141, 0xbfb8aa3b, v107
    v_mul_f32 v146, v109, v109
    v_mul_f32 v142, 0xbfb8aa3b, v109
    v_mul_f32 v147, v111, v111
    v_mul_f32 v143, 0xbfb8aa3b, v111
    v_rcp_f32 v144, v144
    v_rcp_f32 v145, v145
    v_rcp_f32 v146, v146
    v_rcp_f32 v147, v147
    v_fmac_f32 v8, v112, v104
    v_fmac_f32 v9, v113, v104
    v_fmac_f32 v10, v114, v104
    v_fmac_f32 v11, v115, v104
    v_fmac_f32 v12, v112, v106
    s_barrier
    v_fmac_f32 v13, v113, v106
    v_fmac_f32 v14, v114, v106
    v_fmac_f32 v15, v115, v106
    v_fmac_f32 v16, v112, v108
    v_fmac_f32 v17, v113, v108
    v_fmac_f32 v18, v114, v108
    v_fmac_f32 v19, v115, v108
    v_fmac_f32 v20, v112, v110
    v_fmac_f32 v21, v113, v110
    v_fmac_f32 v22, v114, v110
    v_fmac_f32 v23, v115, v110
    v_fmac_f32 v40, v120, v104
    v_fmac_f32 v41, v121, v104
    v_fmac_f32 v42, v122, v104
    v_fmac_f32 v43, v123, v104
    v_fmac_f32 v44, v120, v106
    v_fmac_f32 v45, v121, v106
    v_fmac_f32 v46, v122, v106
    v_fmac_f32 v47, v123, v106
    v_fmac_f32 v48, v120, v108
    v_fmac_f32 v49, v121, v108
    v_fmac_f32 v50, v122, v108
    v_fmac_f32 v51, v123, v108
    v_fmac_f32 v52, v120, v110
    v_fmac_f32 v53, v121, v110
    s_barrier
    v_fmac_f32 v54, v122, v110
    v_fmac_f32 v55, v123, v110
    v_mul_f32 v148, v8, v140
    v_mul_f32 v149, v9, v140
    v_mul_f32 v150, v10, v140
    v_mul_f32 v151, v11, v140
    v_exp_f32 v148, v148
    v_exp_f32 v149, v149
    v_exp_f32 v150, v150
    v_exp_f32 v151, v151
    v_mul_f32 v8, v8, v40
    v_mul_f32 v9, v9, v41
    v_mul_f32 v10, v10, v42
    v_mul_f32 v11, v11, v43
    v_fma_f32 v148, v148, v144, v144
    v_fma_f32 v149, v149, v144, v144
    v_fma_f32 v150, v150, v144, v144
    v_fma_f32 v151, v151, v144, v144
    v_rcp_f32 v148, v148
    v_rcp_f32 v149, v149
    s_barrier
    v_rcp_f32 v150, v150
    v_rcp_f32 v151, v151
    v_mul_f32 v8, v8, v148
    v_mul_f32 v9, v9, v149
    v_mul_f32 v10, v10, v150
    v_mul_f32 v11, v11, v151
    v_cvt_pk_bf16_f32 v152, v8, v9
    v_cvt_pk_bf16_f32 v153, v10, v11
    v_mul_f32 v148, v12, v141
    v_mul_f32 v149, v13, v141
    v_mul_f32 v150, v14, v141
    v_mul_f32 v151, v15, v141
    v_exp_f32 v148, v148
    v_exp_f32 v149, v149
    v_exp_f32 v150, v150
    v_exp_f32 v151, v151
    v_mul_f32 v12, v12, v44
    v_mul_f32 v13, v13, v45
    s_barrier
    v_mul_f32 v14, v14, v46
    v_mul_f32 v15, v15, v47
    v_fma_f32 v148, v148, v145, v145
    v_fma_f32 v149, v149, v145, v145
    v_fma_f32 v150, v150, v145, v145
    v_fma_f32 v151, v151, v145, v145
    v_rcp_f32 v148, v148
    v_rcp_f32 v149, v149
    v_rcp_f32 v150, v150
    v_rcp_f32 v151, v151
    v_mul_f32 v12, v12, v148
    v_mul_f32 v13, v13, v149
    v_mul_f32 v14, v14, v150
    v_mul_f32 v15, v15, v151
    v_cvt_pk_bf16_f32 v154, v12, v13
    v_cvt_pk_bf16_f32 v155, v14, v15
    v_mul_f32 v148, v16, v142
    v_mul_f32 v149, v17, v142
    v_mul_f32 v150, v18, v142
    v_mul_f32 v151, v19, v142
    v_exp_f32 v148, v148
    v_exp_f32 v149, v149
    s_waitcnt vmcnt(0)
    s_barrier
    s_cmp_lg_u32 s3, 0
    s_cbranch_scc1 L1_sga
    v_lshlrev_b32 v3, 2, v0
    s_mov_b32 exec_hi, 0
    buffer_store_dword v1, v3, s[24:27], s67 offen sc1
    s_mov_b64 exec, -1
L1_sga:
    v_exp_f32 v150, v150
    v_exp_f32 v151, v151
    v_mul_f32 v16, v16, v48
    v_mul_f32 v17, v17, v49
    v_mul_f32 v18, v18, v50
    v_mul_f32 v19, v19, v51
    v_fma_f32 v148, v148, v146, v146
    v_fma_f32 v149, v149, v146, v146
    v_fma_f32 v150, v150, v146, v146
    v_fma_f32 v151, v151, v146, v146
    v_rcp_f32 v148, v148
    v_rcp_f32 v149, v149
    v_rcp_f32 v150, v150
    v_rcp_f32 v151, v151
    v_mul_f32 v16, v16, v148
    v_mul_f32 v17, v17, v149
    v_mul_f32 v18, v18, v150
    v_mul_f32 v19, v19, v151
    v_cvt_pk_bf16_f32 v156, v16, v17
    v_cvt_pk_bf16_f32 v157, v18, v19
    v_mul_f32 v148, v20, v143
    s_barrier
    v_mul_f32 v149, v21, v143
    v_mul_f32 v150, v22, v143
    v_mul_f32 v151, v23, v143
    v_exp_f32 v148, v148
    v_exp_f32 v149, v149
    v_exp_f32 v150, v150
    v_exp_f32 v151, v151
    v_mul_f32 v20, v20, v52
    v_mul_f32 v21, v21, v53
    v_mul_f32 v22, v22, v54
    v_mul_f32 v23, v23, v55
    v_fma_f32 v148, v148, v147, v147
    v_fma_f32 v149, v149, v147, v147
    v_fma_f32 v150, v150, v147, v147
    v_fma_f32 v151, v151, v147, v147
    v_rcp_f32 v148, v148
    v_rcp_f32 v149, v149
    v_rcp_f32 v150, v150
    v_rcp_f32 v151, v151
    s_barrier
    v_mul_f32 v20, v20, v148
    v_mul_f32 v21, v21, v149
    v_mul_f32 v22, v22, v150
    v_mul_f32 v23, v23, v151
    v_cvt_pk_bf16_f32 v158, v20, v21
    v_cvt_pk_bf16_f32 v159, v22, v23
    s_nop 0
    v_permlane16_swap_b32 v152, v154
    v_permlane16_swap_b32 v153, v155
    v_permlane16_swap_b32 v156, v158
    v_permlane16_swap_b32 v157, v159
    buffer_store_dwordx4 v[152:155], v2, s[24:27], s68 offen sc1
    s_add_u32 s68, s68, 98304
    buffer_store_dwordx4 v[156:159], v2, s[24:27], s68 offen sc1
    v_fmac_f32 v24, v116, v104
    v_fmac_f32 v25, v117, v104
    v_fmac_f32 v26, v118, v104
    v_fmac_f32 v27, v119, v104
    v_fmac_f32 v28, v116, v106
    v_fmac_f32 v29, v117, v106
    v_fmac_f32 v30, v118, v106
    v_fmac_f32 v31, v119, v106
    v_fmac_f32 v32, v116, v108
    v_fmac_f32 v33, v117, v108
    v_fmac_f32 v34, v118, v108
    v_fmac_f32 v35, v119, v108
    v_fmac_f32 v36, v116, v110
    v_fmac_f32 v37, v117, v110
    s_barrier
    v_fmac_f32 v38, v118, v110
    v_fmac_f32 v39, v119, v110
    v_fmac_f32 v56, v124, v104
    v_fmac_f32 v57, v125, v104
    v_fmac_f32 v58, v126, v104
    v_fmac_f32 v59, v127, v104
    v_fmac_f32 v60, v124, v106
    v_fmac_f32 v61, v125, v106
    v_fmac_f32 v62, v126, v106
    v_fmac_f32 v63, v127, v106
    v_fmac_f32 v64, v124, v108
    v_fmac_f32 v65, v125, v108
    v_fmac_f32 v66, v126, v108
    v_fmac_f32 v67, v127, v108
    v_fmac_f32 v68, v124, v110
    v_fmac_f32 v69, v125, v110
    v_fmac_f32 v70, v126, v110
    v_fmac_f32 v71, v127, v110
    v_mul_f32 v148, v24, v140
    v_mul_f32 v149, v25, v140
    v_mul_f32 v150, v26, v140
    v_mul_f32 v151, v27, v140
    v_exp_f32 v148, v148
    v_exp_f32 v149, v149
    v_exp_f32 v150, v150
    s_barrier
    v_exp_f32 v151, v151
    v_mul_f32 v24, v24, v56
    v_mul_f32 v25, v25, v57
    v_mul_f32 v26, v26, v58
    v_mul_f32 v27, v27, v59
    v_fma_f32 v148, v148, v144, v144
    v_fma_f32 v149, v149, v144, v144
    v_fma_f32 v150, v150, v144, v144
    v_fma_f32 v151, v151, v144, v144
    v_rcp_f32 v148, v148
    v_rcp_f32 v149, v149
    v_rcp_f32 v150, v150
    v_rcp_f32 v151, v151
    v_mul_f32 v24, v24, v148
    v_mul_f32 v25, v25, v149
    v_mul_f32 v26, v26, v150
    v_mul_f32 v27, v27, v151
    v_cvt_pk_bf16_f32 v160, v24, v25
    v_cvt_pk_bf16_f32 v161, v26, v27
    v_mul_f32 v148, v28, v141
    v_mul_f32 v149, v29, v141
    s_barrier
    v_mul_f32 v150, v30, v141
    v_mul_f32 v151, v31, v141
    v_exp_f32 v148, v148
    v_exp_f32 v149, v149
    v_exp_f32 v150, v150
    v_exp_f32 v151, v151
    v_mul_f32 v28, v28, v60
    v_mul_f32 v29, v29, v61
    v_mul_f32 v30, v30, v62
    v_mul_f32 v31, v31, v63
    v_fma_f32 v148, v148, v145, v145
    v_fma_f32 v149, v149, v145, v145
    v_fma_f32 v150, v150, v145, v145
    v_fma_f32 v151, v151, v145, v145
    v_rcp_f32 v148, v148
    v_rcp_f32 v149, v149
    v_rcp_f32 v150, v150
    v_rcp_f32 v151, v151
    v_mul_f32 v28, v28, v148
    s_barrier
    v_mul_f32 v29, v29, v149
    v_mul_f32 v30, v30, v150
    v_mul_f32 v31, v31, v151
    v_cvt_pk_bf16_f32 v162, v28, v29
    v_cvt_pk_bf16_f32 v163, v30, v31
    v_mul_f32 v148, v32, v142
    v_mul_f32 v149, v33, v142
    v_mul_f32 v150, v34, v142
    v_mul_f32 v151, v35, v142
    v_exp_f32 v148, v148
    v_exp_f32 v149, v149
    v_exp_f32 v150, v150
    v_exp_f32 v151, v151
    v_mul_f32 v32, v32, v64
    v_mul_f32 v33, v33, v65
    v_mul_f32 v34, v34, v66
    v_mul_f32 v35, v35, v67
    v_fma_f32 v148, v148, v146, v146
    v_fma_f32 v149, v149, v146, v146
    v_fma_f32 v150, v150, v146, v146
    v_fma_f32 v151, v151, v146, v146
    v_rcp_f32 v148, v148
    s_barrier
    v_rcp_f32 v149, v149
    v_rcp_f32 v150, v150
    v_rcp_f32 v151, v151
    v_mul_f32 v32, v32, v148
    v_mul_f32 v33, v33, v149
    v_mul_f32 v34, v34, v150
    v_mul_f32 v35, v35, v151
    v_cvt_pk_bf16_f32 v164, v32, v33
    v_cvt_pk_bf16_f32 v165, v34, v35
    v_mul_f32 v148, v36, v143
    v_mul_f32 v149, v37, v143
    v_mul_f32 v150, v38, v143
    v_mul_f32 v151, v39, v143
    v_exp_f32 v148, v148
    v_exp_f32 v149, v149
    v_exp_f32 v150, v150
    v_exp_f32 v151, v151
    v_mul_f32 v36, v36, v68
    v_mul_f32 v37, v37, v69
    v_mul_f32 v38, v38, v70
    s_barrier
    v_mul_f32 v39, v39, v71
    v_fma_f32 v148, v148, v147, v147
    v_fma_f32 v149, v149, v147, v147
    v_fma_f32 v150, v150, v147, v147
    v_fma_f32 v151, v151, v147, v147
    v_rcp_f32 v148, v148
    v_rcp_f32 v149, v149
    v_rcp_f32 v150, v150
    v_rcp_f32 v151, v151
    v_mul_f32 v36, v36, v148
    v_mul_f32 v37, v37, v149
    v_mul_f32 v38, v38, v150
    v_mul_f32 v39, v39, v151
    v_cvt_pk_bf16_f32 v166, v36, v37
    v_cvt_pk_bf16_f32 v167, v38, v39
    s_nop 0
    v_permlane16_swap_b32 v160, v162
    v_permlane16_swap_b32 v161, v163
    v_permlane16_swap_b32 v164, v166
    v_permlane16_swap_b32 v165, v167
    buffer_store_dwordx4 v[160:163], v2, s[24:27], s69 offen sc1
    s_add_u32 s69, s69, 98304
    buffer_store_dwordx4 v[164:167], v2, s[24:27], s69 offen sc1
    s_barrier
L1_join:
    v_and_b32 v4, 0x13, v0
    v_bfe_u32 v5, v0, 2, 1
    v_lshl_add_u32 v4, v5, 3, v4
    v_bfe_u32 v5, v0, 3, 1
    v_lshl_add_u32 v4, v5, 2, v4
    v_min_u32 v4, 19, v4
    v_lshrrev_b32 v5, 5, v0
    v_mul_u32_u24 v5, 640, v5
    v_lshl_add_u32 v4, v4, 4, v5
    v_and_b32 v5, 31, v0
    v_cmp_eq_u32 vcc, 20, v5
    v_mov_b32 v5, 0x3f803f80
    s_nop 0
    v_cndmask_b32 v5, 0, v5, vcc
    v_mov_b32 v104, v5
    v_mov_b32 v105, v5
    v_mov_b32 v106, v5
    v_mov_b32 v107, v5
    v_mov_b32 v108, v5
    v_mov_b32 v109, v5
    v_mov_b32 v110, v5
    v_mov_b32 v111, v5
    v_mov_b32 v112, v5
    s_barrier
    v_mov_b32 v113, v5
    v_mov_b32 v114, v5
    v_mov_b32 v115, v5
    v_lshl_add_u32 v3, s8, 3, v2
    v_mov_b32 v5, v2
    v_add_u32 v7, 12288, v4
    v_mov_b32 v6, v3
    v_mov_b32 v40, 0
    v_mov_b32 v41, 0
    v_mov_b32 v42, 0
    v_mov_b32 v43, 0
    v_mov_b32 v44, 0
    v_mov_b32 v45, 0
    v_mov_b32 v46, 0
    v_mov_b32 v47, 0
    v_cmp_gt_u32 vcc, 32, v0
    v_mov_b32 v87, 0xdddddddd
    v_and_b32 v8, 0x1ff, v3
    v_mfma_f32_32x32x16_bf16 v[48:63], v[40:43], v[40:43], 0
    v_add_u32 v10, s45, v2
    v_add_u32 v11, s47, v8
    v_mov_b32 v9, 0xff800000
    s_barrier
    s_branch L2_attn
L1_g1:
    s_setprio 2
    s_sub_u32 s67, s3, 4
    s_and_b32 s60, s67, 1
    s_cselect_b32 s61, s56, s55
    s_cmp_lt_u32 s67, 2
    s_cselect_b32 s61, s61, s57
    s_cselect_b32 s62, s53, 8
    s_cmp_lt_u32 s62, 8
    s_movk_i32 s63, 3840
    s_cselect_b32 s63, 3072, s63
    v_lshl_add_u32 v129, v0, 4, s52
    s_lshl_b32 s61, s61, 7
    v_mul_u32_u24 v128, s63, v129
    v_add_u32 v128, s61, v128
    s_lshl_b32 s48, s52, 4
    s_add_u32 s48, s48, s53
    s_lshl_b32 s48, s48, 2
    s_add_u32 s48, s48, s67
    s_mul_i32 s51, s48, 2560
    v_mov_b32 v152, 0
    v_mov_b32 v153, 0
    v_mov_b32 v154, 0
    v_mov_b32 v155, 0
    v_bfe_u32 v3, v0, 3, 1
    v_mul_u32_u24 v3, 1280, v3
    v_lshl_add_u32 v3, v1, 7, v3
    v_and_b32 v4, 7, v0
    v_lshl_add_u32 v133, v4, 4, v3
    s_mov_b32 s30, 2621440
    s_mov_b32 s31, 0x00020000
    s_cmp_lg_u32 s60, 0
    s_waitcnt lgkmcnt(0)
    s_cselect_b64 s[40:41], s[14:15], s[12:13]
    s_cmp_lt_u32 s62, 8
    s_cselect_b64 s[42:43], s[40:41], s[6:7]
    s_mov_b64 s[28:29], s[4:5]
    v_lshrrev_b32 v3, 4, v0
    v_lshlrev_b32 v120, 10, v3
    v_xor_b32 v3, s67, v3
    v_and_b32 v3, 1, v3
    v_lshl_add_u32 v120, v3, 5, v120
    v_bfe_u32 v3, v0, 2, 2
    v_lshl_add_u32 v120, v3, 6, v120
    v_and_b32 v3, 3, v0
    v_lshl_add_u32 v120, v3, 3, v120
    s_lshr_b32 s10, s67, 1
    s_lshl_b32 s10, s10, 8
    v_add_u32 v120, s10, v120
    v_add_u32 v120, 98304, v120
    v_mov_b32 v156, 0x3f803f80
    v_mov_b32 v157, 0x3f803f80
    v_mov_b32 v158, 0x3f803f80
    v_mov_b32 v159, 0x3f803f80
    v_bfe_u32 v3, v0, 1, 3
    v_lshrrev_b32 v4, 5, v0
    v_cmp_eq_u32 vcc, v3, v4
    v_and_b32 v3, 1, v0
    v_mul_u32_u24 v3, 0xaaaa, v3
    v_cndmask_b32 v160, 0, v156, vcc
    v_cndmask_b32 v161, 0, v156, vcc
    v_cndmask_b32 v162, 0, v156, vcc
    v_cndmask_b32 v163, 0, v156, vcc
    v_add_u32 v94, 0x4444, v3
    v_mov_b32 v84, 0
    v_mov_b32 v85, 0
    v_mov_b32 v86, 0
    v_mov_b32 v87, 0
    v_mov_b32 v88, 0
    v_mov_b32 v89, 0
    v_mov_b32 v90, 0
    v_mov_b32 v91, 0
    s_cmp_ge_u32 s67, 3
    s_cbranch_scc1 L1_t1
    s_mov_b32 exec_lo, 0xff0
    s_mov_b32 exec_hi, 0x0
    global_load_dword v95, v128, s[42:43]
    s_mov_b64 exec, -1
L1_t1:
    s_cmp_ge_u32 s67, 3
    s_cbranch_scc1 L1_t2
    s_mov_b32 exec_lo, 0x3ff000
    s_mov_b32 exec_hi, 0x0
    global_load_dword v95, v128, s[42:43]
    s_mov_b64 exec, -1
L1_t2:
    buffer_load_dwordx4 v[144:147], v133, s[28:31], s51 offen
    buffer_load_dwordx4 v[148:151], v133, s[28:31], s51 offen offset:512
    s_mov_b32 exec_hi, 0
    buffer_load_dwordx4 v[152:155], v133, s[28:31], s51 offen offset:1024
    s_mov_b32 exec_hi, -1
    s_mov_b32 s24, s22
    s_mov_b32 s25, s23
    s_mov_b32 s26, 22675456
    s_mov_b32 s27, 0x00020000
    s_lshl_b32 s49, s53, 4
    s_add_u32 s49, s49, s52
    s_lshl_b32 s49, s49, 7
    s_add_u32 s49, s49, 22183936
    s_lshl_b32 s46, s48, 7
    s_add_u32 s46, s46, 22282240
    s_sub_u32 s10, s46, s49
    v_mul_lo_u32 v3, v0, s10
    s_mov_b64 exec, 3
    buffer_load_dword v167, v3, s[24:27], s49 offen sc1
    s_mov_b64 exec, -1
    s_setprio 0
    s_barrier
    ds_read_b64_tr_b16 v[104:105], v120 offset:0
    ds_read_b64_tr_b16 v[106:107], v120 offset:512
    ds_read_b64_tr_b16 v[108:109], v120 offset:4096
    ds_read_b64_tr_b16 v[110:111], v120 offset:4608
    ds_read_b64_tr_b16 v[112:113], v120 offset:8192
    ds_read_b64_tr_b16 v[114:115], v120 offset:8704
    s_mov_b32 s36, s20
    s_mov_b32 s37, s21
    s_mov_b32 s38, 256
    s_mov_b32 s39, 0x00020000
    v_mov_b32 v166, 0
    s_and_b32 s58, s2, 7
    s_xor_b32 s58, s58, 1
    s_lshr_b32 s59, s2, 3
    s_and_b32 s60, s58, 3
    s_lshl_b32 s60, s60, 1
    s_lshr_b32 s61, s59, 4
    s_add_u32 s60, s60, s61
    s_lshl_b32 s61, s60, 2
    s_mov_b32 s60, 0xc7549310
    s_and_b32 s62, s59, 8
    s_cselect_b32 s60, 0xfdb6ea82, s60
    s_lshr_b32 s61, s60, s61
    s_and_b32 s64, s61, 15
    s_lshl_b32 s58, s64, 1
    s_add_u32 s59, s64, 8
    s_xor_b32 s59, s59, 4
    s_add_u32 s58, s58, 1
    s_cmp_lt_u32 s64, 8
    s_cselect_b32 s50, s58, s59
    s_sub_u32 s59, s64, 8
    s_mul_i32 s59, s59, 3
    s_xor_b32 s58, s58, 1
    s_add_u32 s60, s59, 1
    s_add_u32 s61, s59, 2
    s_add_u32 s62, s64, 20
    s_add_u32 s63, s64, 14
    s_min_u32 s59, s59, 19
    s_waitcnt lgkmcnt(0)
    v_smfmac_f32_16x16x64_bf16 v[84:87], v[160:163], v[104:111], v94
    s_barrier
    ds_read_b64_tr_b16 v[104:105], v120 offset:12288
    ds_read_b64_tr_b16 v[106:107], v120 offset:12800
    ds_read_b64_tr_b16 v[108:109], v120 offset:16384
    ds_read_b64_tr_b16 v[110:111], v120 offset:16896
    ds_read_b64_tr_b16 v[116:117], v120 offset:20480
    ds_read_b64_tr_b16 v[118:119], v120 offset:20992
    s_cmp_lt_u32 s64, 14
    s_cselect_b32 s61, s61, s63
    s_cmp_lt_u32 s64, 8
    s_cselect_b32 s65, s58, s59
    s_cselect_b32 s66, s58, s60
    s_cselect_b32 s68, s62, s61
    s_and_b32 s60, s67, 1
    s_cselect_b32 s61, s66, s65
    s_cmp_lt_u32 s67, 2
    s_cselect_b32 s61, s61, s68
    s_cselect_b32 s62, s64, 8
    s_cmp_lt_u32 s62, 8
    s_movk_i32 s63, 3840
    s_cselect_b32 s63, 3072, s63
    s_cselect_b64 s[20:21], s[40:41], s[6:7]
    v_mul_u32_u24 v130, s63, v129
    v_lshl_add_u32 v130, s61, 7, v130
    s_and_b32 s58, s3, 1
    s_bfe_u32 s59, s3, 0x10001
    s_lshl_b32 s63, s52, 1
    s_add_u32 s63, s63, s59
    s_lshl_b32 s63, s63, 1
    s_lshl_b32 s64, s58, 1
    s_mov_b32 s61, 0
    s_mov_b32 s62, 5
    s_mov_b32 s32, s18
    s_mov_b32 s33, s19
    s_mov_b32 s34, 2621440
    s_mov_b32 s35, 0x00020000
    s_and_b32 s11, s2, 7
    s_lshr_b32 s10, s2, 3
    s_and_b32 s7, s10, 7
    s_and_b32 s14, s10, 3
    s_lshr_b32 s13, s10, 2
    s_lshl_b32 s6, s11, 3
    s_add_u32 s13, s13, s6
    s_lshr_b32 s10, s10, 3
    s_lshl_b32 s11, s11, 2
    s_add_u32 s6, s11, s10
    s_and_b32 s8, s6, 1
    s_lshr_b32 s11, s6, 1
    s_mul_i32 s11, s11, 5
    s_add_u32 s12, s11, 2
    s_mul_i32 s10, s8, 3
    s_add_u32 s9, s11, s10
    s_and_b32 s16, s3, 3
    s_mul_i32 s15, s14, 10
    s_add_u32 s15, s15, s16
    s_mul_i32 s15, s15, 20
    s_lshr_b32 s11, s3, 2
    s_mul_i32 s11, s11, 6
    s_add_u32 s15, s15, s11
    s_lshl_b32 s15, s15, 10
    s_add_u32 s15, s15, 21364736
    s_mul_i32 s17, s13, 40960
    s_mul_i32 s11, s14, 320
    s_add_u32 s17, s17, s11
    s_mov_b32 s4, 0x000fffff
    s_mov_b32 s5, 0x000fffff
    s_lshl_b32 s18, s7, 3
    s_add_u32 s18, s18, s3
    s_lshr_b32 s47, s3, 1
    s_mul_i32 s47, s47, 3072
    s_and_b32 s11, s3, 1
    s_lshl_b32 s45, s11, 10
    s_waitcnt lgkmcnt(0)
    v_smfmac_f32_16x16x64_bf16 v[84:87], v[160:163], v[104:111], v94
    v_smfmac_f32_16x16x64_bf16 v[88:91], v[160:163], v[112:119], v94
    s_barrier
    ds_read_b64_tr_b16 v[104:105], v120 offset:24576
    ds_read_b64_tr_b16 v[106:107], v120 offset:25088
    ds_read_b64_tr_b16 v[108:109], v120 offset:28672
    ds_read_b64_tr_b16 v[110:111], v120 offset:29184
    ds_read_b64_tr_b16 v[112:113], v120 offset:32768
    ds_read_b64_tr_b16 v[114:115], v120 offset:33280
    s_add_u32 s45, s45, s47
    s_lshl_b32 s11, s11, 9
    s_add_u32 s47, s47, s11
    s_mov_b32 s19, 0
    s_mov_b32 s44, 8
    v_lshrrev_b32 v4, 4, v0
    v_lshlrev_b32 v2, 10, v4
    v_xor_b32 v4, s64, v4
    v_and_b32 v4, 1, v4
    v_lshl_add_u32 v2, v4, 5, v2
    v_bfe_u32 v4, v0, 2, 2
    v_lshl_add_u32 v2, v4, 6, v2
    v_and_b32 v4, 3, v0
    v_lshl_add_u32 v2, v4, 3, v2
    s_lshr_b32 s10, s64, 1
    s_lshl_b32 s10, s10, 8
    v_add_u32 v2, s10, v2
    v_and_b32 v4, 15, v0
    v_bfe_u32 v5, v0, 1, 3
    v_xor_b32 v5, v5, v1
    v_lshlrev_b32 v5, 4, v5
    v_lshl_add_u32 v5, v4, 7, v5
    s_lshl_b32 s10, s59, 13
    v_add_u32 v5, s10, v5
    v_and_b32 v3, 3, v0
    v_lshl_add_u32 v3, s67, 2, v3
    v_lshl_add_u32 v3, v3, 4, s52
    s_mov_b32 s10, 22183936
    v_lshl_add_u32 v132, v3, 7, s10
    s_lshl_b32 s11, s54, 7
    v_mul_u32_u24 v129, 3072, v129
    v_lshl_add_u32 v131, s50, 7, v129
    v_add_u32 v129, s11, v129
    s_waitcnt lgkmcnt(0)
    v_smfmac_f32_16x16x64_bf16 v[84:87], v[160:163], v[104:111], v94
    s_barrier
    ds_read_b64_tr_b16 v[104:105], v120 offset:36864
    ds_read_b64_tr_b16 v[106:107], v120 offset:37376
    ds_read_b64_tr_b16 v[108:109], v120 offset:40960
    ds_read_b64_tr_b16 v[110:111], v120 offset:41472
    ds_read_b64_tr_b16 v[116:117], v120 offset:45056
    ds_read_b64_tr_b16 v[118:119], v120 offset:45568
    s_waitcnt vmcnt(0)
    s_bitcmp1_b32 s2, 0
    s_cbranch_scc1 L1_t3
    s_cmp_ge_u32 s67, 3
    s_cbranch_scc1 L1_t3
    s_mov_b32 exec_lo, 0xffc00000
    s_mov_b32 exec_hi, 0xff
    global_load_dword v95, v128, s[42:43]
    global_load_dword v95, v130, s[20:21]
    s_mov_b64 exec, -1
L1_t3:
    s_waitcnt lgkmcnt(0)
    v_smfmac_f32_16x16x64_bf16 v[84:87], v[160:163], v[104:111], v94
    v_smfmac_f32_16x16x64_bf16 v[88:91], v[160:163], v[112:119], v94
    v_mfma_f32_16x16x32_bf16 v[140:143], v[144:147], v[144:147], 0
    v_mfma_f32_16x16x32_bf16 v[136:139], v[156:159], v[144:147], 0
    v_mfma_f32_16x16x32_bf16 v[140:143], v[148:151], v[148:151], v[140:143]
    v_mfma_f32_16x16x32_bf16 v[136:139], v[156:159], v[148:151], v[136:139]
    v_mfma_f32_16x16x32_bf16 v[140:143], v[152:155], v[152:155], v[140:143]
    v_mfma_f32_16x16x32_bf16 v[136:139], v[156:159], v[152:155], v[136:139]
    s_barrier
    ds_read_b64_tr_b16 v[104:105], v120 offset:49152
    ds_read_b64_tr_b16 v[106:107], v120 offset:49664
    ds_read_b64_tr_b16 v[108:109], v120 offset:53248
    ds_read_b64_tr_b16 v[110:111], v120 offset:53760
    ds_read_b64_tr_b16 v[112:113], v120 offset:57344
    ds_read_b64_tr_b16 v[114:115], v120 offset:57856
    v_and_b32 v3, 1, v0
    v_cmp_eq_u32 vcc, 1, v3
    v_bfe_u32 v3, v0, 1, 1
    v_bfe_u32 v4, v0, 2, 2
    s_nop 3
    v_cndmask_b32 v140, v140, v141, vcc
    v_cndmask_b32 v142, v142, v143, vcc
    v_cmp_eq_u32 vcc, 1, v3
    s_nop 1
    v_cndmask_b32 v140, v140, v142, vcc
    v_cmp_eq_u32 vcc, v4, v1
    s_nop 1
    v_cndmask_b32 v140, 0, v140, vcc
    s_nop 1
    v_add_f32_dpp v140, v140, v140 quad_perm:[1,0,3,2] row_mask:0xf bank_mask:0xf
    s_waitcnt lgkmcnt(0)
    v_smfmac_f32_16x16x64_bf16 v[84:87], v[160:163], v[104:111], v94
    s_barrier
    ds_read_b64_tr_b16 v[104:105], v120 offset:0
    ds_read_b64_tr_b16 v[106:107], v120 offset:512
    ds_read_b64_tr_b16 v[108:109], v120 offset:4096
    ds_read_b64_tr_b16 v[110:111], v120 offset:4608
    ds_read_b64_tr_b16 v[116:117], v120 offset:8192
    ds_read_b64_tr_b16 v[118:119], v120 offset:8704
    v_add_f32_dpp v136, v136, v136 quad_perm:[1,0,3,2] row_mask:0xf bank_mask:0xf
    s_nop 1
    v_add_f32_dpp v140, v140, v140 quad_perm:[2,3,0,1] row_mask:0xf bank_mask:0xf
    v_add_f32_dpp v136, v136, v136 quad_perm:[2,3,0,1] row_mask:0xf bank_mask:0xf
    s_nop 1
    v_add_f32_dpp v140, v140, v140 row_half_mirror row_mask:0xf bank_mask:0xf
    v_add_f32_dpp v136, v136, v136 row_half_mirror row_mask:0xf bank_mask:0xf
    v_mov_b32 v3, v140
    s_nop 1
    v_permlane16_swap_b32 v3, v140
    s_nop 0
    v_add_f32 v140, v3, v140
    v_mov_b32 v3, v140
    s_nop 1
    v_permlane32_swap_b32 v3, v140
    s_nop 0
    s_waitcnt lgkmcnt(0)
    v_smfmac_f32_16x16x64_bf16 v[84:87], v[160:163], v[104:111], v94
    v_smfmac_f32_16x16x64_bf16 v[88:91], v[160:163], v[112:119], v94
    s_barrier
    ds_read_b64_tr_b16 v[104:105], v120 offset:12288
    ds_read_b64_tr_b16 v[106:107], v120 offset:12800
    ds_read_b64_tr_b16 v[108:109], v120 offset:16384
    ds_read_b64_tr_b16 v[110:111], v120 offset:16896
    ds_read_b64_tr_b16 v[112:113], v120 offset:20480
    ds_read_b64_tr_b16 v[114:115], v120 offset:20992
    v_add_f32 v140, v3, v140
    v_mul_f32 v136, 0xbacccccd, v136
    v_mul_f32 v137, 0x3acccccd, v140
    v_fma_f32 v137, -v136, v136, v137
    v_max_f32 v137, 0, v137
    v_cvt_pk_bf16_f32 v136, v136, v137
    v_and_b32 v137, 0xffff0000, v136
    v_lshlrev_b32 v136, 16, v136
    v_add_f32 v137, 0x3727c5ac, v137
    v_cvt_pk_bf16_f32 v137, v137, v137
    v_lshlrev_b32 v137, 16, v137
    v_sqrt_f32 v137, v137
    v_and_b32 v3, 8, v0
    v_cvt_pk_bf16_f32 v137, v137, v137
    v_lshlrev_b32 v137, 16, v137
    v_rcp_f32 v137, v137
    s_mov_b64 exec, 0x101
    buffer_store_dwordx2 v[136:137], v3, s[24:27], s46 offen sc1
    s_mov_b64 exec, 15
    buffer_load_dword v167, v166, s[36:39], 0 offen sc1
    s_mov_b64 exec, -1
    s_waitcnt lgkmcnt(0)
    v_smfmac_f32_16x16x64_bf16 v[84:87], v[160:163], v[104:111], v94
    s_barrier
    ds_read_b64_tr_b16 v[104:105], v120 offset:24576
    ds_read_b64_tr_b16 v[106:107], v120 offset:25088
    ds_read_b64_tr_b16 v[108:109], v120 offset:28672
    ds_read_b64_tr_b16 v[110:111], v120 offset:29184
    ds_read_b64_tr_b16 v[116:117], v120 offset:32768
    ds_read_b64_tr_b16 v[118:119], v120 offset:33280
    s_waitcnt lgkmcnt(0)
    v_smfmac_f32_16x16x64_bf16 v[84:87], v[160:163], v[104:111], v94
    v_smfmac_f32_16x16x64_bf16 v[88:91], v[160:163], v[112:119], v94
    s_barrier
    ds_read_b64_tr_b16 v[104:105], v120 offset:36864
    ds_read_b64_tr_b16 v[106:107], v120 offset:37376
    ds_read_b64_tr_b16 v[108:109], v120 offset:40960
    ds_read_b64_tr_b16 v[110:111], v120 offset:41472
    ds_read_b64_tr_b16 v[112:113], v120 offset:45056
    ds_read_b64_tr_b16 v[114:115], v120 offset:45568
    s_waitcnt vmcnt(0)
    s_waitcnt lgkmcnt(0)
    v_smfmac_f32_16x16x64_bf16 v[84:87], v[160:163], v[104:111], v94
    s_barrier
    ds_read_b64_tr_b16 v[104:105], v120 offset:49152
    ds_read_b64_tr_b16 v[106:107], v120 offset:49664
    ds_read_b64_tr_b16 v[108:109], v120 offset:53248
    ds_read_b64_tr_b16 v[110:111], v120 offset:53760
    ds_read_b64_tr_b16 v[116:117], v120 offset:57344
    ds_read_b64_tr_b16 v[118:119], v120 offset:57856
    s_mov_b64 exec, 15
    s_waitcnt vmcnt(0)
    v_cmp_eq_u32 vcc, 0, v167
    s_cbranch_vccz L1_rdy_x
    s_mov_b32 s10, 262144
L1_rdy:
    buffer_load_dword v167, v166, s[36:39], 0 offen sc1
    s_sub_u32 s10, s10, 1
    s_waitcnt vmcnt(0)
    v_cmp_eq_u32 vcc, 0, v167
    s_cbranch_scc1 L1_rdy_x
    s_cbranch_vccnz L1_rdy
L1_rdy_x:
    s_cmp_lg_u32 s67, 0
    s_cbranch_scc1 L1_nosig
    s_mov_b64 exec, 1
    buffer_store_dword v167, v166, s[24:27], s49 offen sc1
L1_nosig:
    s_mov_b64 exec, -1
    s_waitcnt lgkmcnt(0)
    v_smfmac_f32_16x16x64_bf16 v[84:87], v[160:163], v[104:111], v94
    v_smfmac_f32_16x16x64_bf16 v[88:91], v[160:163], v[112:119], v94
    s_barrier
    ds_read_b64_tr_b16 v[104:105], v120 offset:0
    ds_read_b64_tr_b16 v[106:107], v120 offset:512
    ds_read_b64_tr_b16 v[108:109], v120 offset:4096
    ds_read_b64_tr_b16 v[110:111], v120 offset:4608
    ds_read_b64_tr_b16 v[112:113], v120 offset:8192
    ds_read_b64_tr_b16 v[114:115], v120 offset:8704
    s_mul_i32 s68, s63, 192
    s_lshl_b32 s10, s54, 3
    s_add_u32 s68, s68, s10
    s_lshl_b32 s10, s58, 2
    s_add_u32 s68, s68, s10
    s_lshl_b32 s68, s68, 9
    s_add_u32 s68, s68, 10485760
    s_lshl_b32 s10, s59, 10
    s_sub_u32 s69, s68, s10
    s_add_u32 s69, s69, 1024
    s_add_u32 s68, s68, s10
    s_lshl_b32 s10, s59, 5
    v_xor_b32 v2, s10, v2
    s_mov_b32 s60, 98304
    s_mov_b32 s61, 65536
    v_mov_b32 v80, 0
    v_mov_b32 v81, 0
    v_mov_b32 v82, 0
    v_mov_b32 v83, 0
    v_mov_b32 v164, 162048
    s_lshl_b32 s10, s58, 1
    s_add_u32 s10, s10, s59
    s_lshl_b32 s10, s10, 6
    s_add_u32 s10, s10, 159744
    v_lshl_add_u32 v166, v1, 4, s10
    v_lshl_add_u32 v93, v0, 2, s10
    s_lshl_b32 s11, s67, 6
    s_add_u32 s11, s11, 160256
    v_lshl_add_u32 v134, v0, 2, s11
    v_and_b32 v3, 15, v0
    s_lshl_b32 s11, s59, 9
    s_add_u32 s11, s11, 161024
    v_lshl_add_u32 v135, v3, 3, s11
    s_waitcnt lgkmcnt(0)
    v_smfmac_f32_16x16x64_bf16 v[84:87], v[160:163], v[104:111], v94
    s_barrier
    ds_read_b64_tr_b16 v[104:105], v120 offset:12288
    ds_read_b64_tr_b16 v[106:107], v120 offset:12800
    ds_read_b64_tr_b16 v[108:109], v120 offset:16384
    ds_read_b64_tr_b16 v[110:111], v120 offset:16896
    ds_read_b64_tr_b16 v[116:117], v120 offset:20480
    ds_read_b64_tr_b16 v[118:119], v120 offset:20992
    v_and_b32 v152, 0x13, v0
    v_bfe_u32 v153, v0, 2, 1
    v_lshl_add_u32 v152, v153, 3, v152
    v_bfe_u32 v153, v0, 3, 1
    v_lshl_add_u32 v152, v153, 2, v152
    v_min_u32 v152, 19, v152
    v_lshrrev_b32 v153, 5, v0
    v_mul_u32_u24 v153, 640, v153
    v_lshl_add_u32 v152, v152, 4, v153
    v_and_b32 v153, 31, v0
    v_cmp_eq_u32 vcc, 20, v153
    v_mov_b32 v153, 0x3f803f80
    s_nop 0
    v_cndmask_b32 v153, 0, v153, vcc
    s_waitcnt lgkmcnt(0)
    v_smfmac_f32_16x16x64_bf16 v[84:87], v[160:163], v[104:111], v94
    v_smfmac_f32_16x16x64_bf16 v[88:91], v[160:163], v[112:119], v94
    s_barrier
    ds_read_b64_tr_b16 v[104:105], v120 offset:24576
    ds_read_b64_tr_b16 v[106:107], v120 offset:25088
    ds_read_b64_tr_b16 v[108:109], v120 offset:28672
    ds_read_b64_tr_b16 v[110:111], v120 offset:29184
    ds_read_b64_tr_b16 v[112:113], v120 offset:32768
    ds_read_b64_tr_b16 v[114:115], v120 offset:33280
    s_waitcnt lgkmcnt(0)
    v_smfmac_f32_16x16x64_bf16 v[84:87], v[160:163], v[104:111], v94
    s_barrier
    ds_read_b64_tr_b16 v[104:105], v120 offset:36864
    ds_read_b64_tr_b16 v[106:107], v120 offset:37376
    ds_read_b64_tr_b16 v[108:109], v120 offset:40960
    ds_read_b64_tr_b16 v[110:111], v120 offset:41472
    ds_read_b64_tr_b16 v[116:117], v120 offset:45056
    ds_read_b64_tr_b16 v[118:119], v120 offset:45568
    v_mov_b32 v8, 0
    v_mov_b32 v9, 0
    v_mov_b32 v10, 0
    v_mov_b32 v11, 0
    v_mov_b32 v12, 0
    v_mov_b32 v13, 0
    v_mov_b32 v14, 0
    v_mov_b32 v15, 0
    v_mov_b32 v16, 0
    v_mov_b32 v17, 0
    v_mov_b32 v18, 0
    v_mov_b32 v19, 0
    v_mov_b32 v20, 0
    v_mov_b32 v21, 0
    v_mov_b32 v22, 0
    v_mov_b32 v23, 0
    v_mov_b32 v24, 0
    v_mov_b32 v25, 0
    v_mov_b32 v26, 0
    v_mov_b32 v27, 0
    v_mov_b32 v28, 0
    v_mov_b32 v29, 0
    s_waitcnt lgkmcnt(0)
    v_smfmac_f32_16x16x64_bf16 v[84:87], v[160:163], v[104:111], v94
    v_smfmac_f32_16x16x64_bf16 v[88:91], v[160:163], v[112:119], v94
    s_barrier
    ds_read_b64_tr_b16 v[104:105], v120 offset:49152
    ds_read_b64_tr_b16 v[106:107], v120 offset:49664
    ds_read_b64_tr_b16 v[108:109], v120 offset:53248
    ds_read_b64_tr_b16 v[110:111], v120 offset:53760
    ds_read_b64_tr_b16 v[112:113], v120 offset:57344
    ds_read_b64_tr_b16 v[114:115], v120 offset:57856
    s_mov_b64 exec, 15
    buffer_load_dword v165, v132, s[24:27], 0 offen sc1
    s_mov_b64 exec, -1
    s_bitcmp1_b32 s2, 0
    s_cbranch_scc1 L1_tb
    s_cmp_lt_u32 s67, 2
    s_cselect_b32 exec_hi, 0xff, 0
    s_mov_b32 s10, 0xfffff
    s_cselect_b32 exec_lo, 0xfff00000, s10
    global_load_dword v95, v129, s[40:41]
    global_load_dword v95, v131, s[40:41]
    s_mov_b64 exec, -1
L1_tb:
    s_waitcnt lgkmcnt(0)
    v_smfmac_f32_16x16x64_bf16 v[84:87], v[160:163], v[104:111], v94
    s_barrier
    ds_read_b64_tr_b16 v[104:105], v120 offset:0
    ds_read_b64_tr_b16 v[106:107], v120 offset:512
    ds_read_b64_tr_b16 v[108:109], v120 offset:4096
    ds_read_b64_tr_b16 v[110:111], v120 offset:4608
    ds_read_b64_tr_b16 v[116:117], v120 offset:8192
    ds_read_b64_tr_b16 v[118:119], v120 offset:8704
    v_mov_b32 v30, 0
    v_mov_b32 v31, 0
    v_mov_b32 v32, 0
    v_mov_b32 v33, 0
    v_mov_b32 v34, 0
    v_mov_b32 v35, 0
    v_mov_b32 v36, 0
    v_mov_b32 v37, 0
    v_mov_b32 v38, 0
    v_mov_b32 v39, 0
    v_mov_b32 v40, 0
    v_mov_b32 v41, 0
    v_mov_b32 v42, 0
    v_mov_b32 v43, 0
    v_mov_b32 v44, 0
    v_mov_b32 v45, 0
    v_mov_b32 v46, 0
    v_mov_b32 v47, 0
    v_mov_b32 v48, 0
    v_mov_b32 v49, 0
    v_mov_b32 v50, 0
    s_waitcnt lgkmcnt(0)
    v_smfmac_f32_16x16x64_bf16 v[84:87], v[160:163], v[104:111], v94
    v_smfmac_f32_16x16x64_bf16 v[88:91], v[160:163], v[112:119], v94
    s_barrier
    ds_read_b64_tr_b16 v[104:105], v120 offset:12288
    ds_read_b64_tr_b16 v[106:107], v120 offset:12800
    ds_read_b64_tr_b16 v[108:109], v120 offset:16384
    ds_read_b64_tr_b16 v[110:111], v120 offset:16896
    ds_read_b64_tr_b16 v[112:113], v120 offset:20480
    ds_read_b64_tr_b16 v[114:115], v120 offset:20992
    s_mov_b64 exec, 15
    s_waitcnt vmcnt(2)
    s_bitcmp1_b32 s2, 0
    s_cbranch_scc0 L1_fw
    s_waitcnt vmcnt(0)
L1_fw:
    v_cmp_ne_u32 vcc, v167, v165
    s_cbranch_vccz L1_g_x
    s_mov_b32 s10, 262144
L1_g:
    buffer_load_dword v165, v132, s[24:27], 0 offen sc1
    s_sub_u32 s10, s10, 1
    s_waitcnt vmcnt(0)
    v_cmp_ne_u32 vcc, v167, v165
    s_cbranch_scc1 L1_g_x
    s_cbranch_vccnz L1_g
L1_g_x:
    s_mov_b64 exec, 0xffff
    s_lshl_b32 s10, s67, 8
    s_add_u32 m0, s10, 161024
    s_lshl_b32 s11, s52, 10
    s_add_u32 s11, s10, s11
    s_lshl_b32 s11, s11, 3
    s_add_u32 s11, s11, 22282240
    v_lshlrev_b32 v4, 7, v0
    buffer_load_dwordx4 v4, s[24:27], s11 offen sc1 lds
    s_mov_b64 exec, -1
    s_waitcnt lgkmcnt(0)
    v_smfmac_f32_16x16x64_bf16 v[84:87], v[160:163], v[104:111], v94
    s_barrier
    ds_read_b64_tr_b16 v[104:105], v120 offset:24576
    ds_read_b64_tr_b16 v[106:107], v120 offset:25088
    ds_read_b64_tr_b16 v[108:109], v120 offset:28672
    ds_read_b64_tr_b16 v[110:111], v120 offset:29184
    ds_read_b64_tr_b16 v[116:117], v120 offset:32768
    ds_read_b64_tr_b16 v[118:119], v120 offset:33280
    v_mov_b32 v51, 0
    v_mov_b32 v52, 0
    v_mov_b32 v53, 0
    v_mov_b32 v54, 0
    v_mov_b32 v55, 0
    v_mov_b32 v56, 0
    v_mov_b32 v57, 0
    v_mov_b32 v58, 0
    v_mov_b32 v59, 0
    v_mov_b32 v60, 0
    v_mov_b32 v61, 0
    v_mov_b32 v62, 0
    v_mov_b32 v63, 0
    v_mov_b32 v64, 0
    v_mov_b32 v65, 0
    v_mov_b32 v66, 0
    v_mov_b32 v67, 0
    v_mov_b32 v68, 0
    v_mov_b32 v69, 0
    v_mov_b32 v70, 0
    v_mov_b32 v71, 0
    s_waitcnt lgkmcnt(0)
    v_smfmac_f32_16x16x64_bf16 v[84:87], v[160:163], v[104:111], v94
    v_smfmac_f32_16x16x64_bf16 v[88:91], v[160:163], v[112:119], v94
    s_barrier
    ds_read_b64_tr_b16 v[104:105], v120 offset:36864
    ds_read_b64_tr_b16 v[106:107], v120 offset:37376
    ds_read_b64_tr_b16 v[108:109], v120 offset:40960
    ds_read_b64_tr_b16 v[110:111], v120 offset:41472
    ds_read_b64_tr_b16 v[112:113], v120 offset:45056
    ds_read_b64_tr_b16 v[114:115], v120 offset:45568
    v_add_u32 v3, s60, v2
    v_xor_b32 v4, 32, v3
    v_add_u32 v6, s61, v5
    v_xor_b32 v7, 64, v6
    s_add_u32 s60, s60, 12288
    s_cmp_eq_u32 s60, 159744
    s_cselect_b32 s60, 98304, s60
    s_add_u32 s61, s61, 16384
    s_cmp_eq_u32 s61, 98304
    s_cselect_b32 s61, 0, s61
    s_waitcnt vmcnt(0)
    s_waitcnt lgkmcnt(0)
    v_smfmac_f32_16x16x64_bf16 v[84:87], v[160:163], v[104:111], v94
    s_barrier
    ds_read_b64_tr_b16 v[104:105], v120 offset:49152
    ds_read_b64_tr_b16 v[106:107], v120 offset:49664
    ds_read_b64_tr_b16 v[108:109], v120 offset:53248
    ds_read_b64_tr_b16 v[110:111], v120 offset:53760
    ds_read_b64_tr_b16 v[116:117], v120 offset:57344
    ds_read_b64_tr_b16 v[118:119], v120 offset:57856
    ds_read_b64 v[72:73], v135 offset:0
    ds_read_b64 v[74:75], v135 offset:128
    ds_read_b64 v[76:77], v135 offset:256
    ds_read_b64 v[78:79], v135 offset:384
    s_waitcnt lgkmcnt(0)
    v_mul_f32 v97, v73, v73
    v_mul_f32 v96, 0xbfb8aa3b, v73
    v_mul_f32 v99, v75, v75
    v_mul_f32 v98, 0xbfb8aa3b, v75
    v_mul_f32 v101, v77, v77
    v_mul_f32 v100, 0xbfb8aa3b, v77
    v_mul_f32 v103, v79, v79
    v_mul_f32 v102, 0xbfb8aa3b, v79
    v_rcp_f32 v97, v97
    v_rcp_f32 v99, v99
    v_rcp_f32 v101, v101
    v_rcp_f32 v103, v103
    v_smfmac_f32_16x16x64_bf16 v[84:87], v[160:163], v[104:111], v94
    v_smfmac_f32_16x16x64_bf16 v[88:91], v[160:163], v[112:119], v94
    s_setprio 1
    s_barrier
    s_nop 5
    v_add_f32 v84, v84, v85
    v_add_f32 v86, v86, v87
    v_add_f32 v88, v88, v89
    v_add_f32 v90, v90, v91
    v_add_f32 v88, v88, v90
    s_mov_b64 exec, 0xffff
    ds_write_b32 v134, v84 offset:0
    ds_write_b32 v134, v86 offset:256
    ds_write_b32 v134, v88 offset:512
    s_mov_b64 exec, 1
    ds_write_b32 v164, v167 offset:8
    s_mov_b64 exec, -1
    ds_read_b128 v[104:107], v6 offset:0
    ds_read_b128 v[108:111], v6 offset:2048
    ds_read_b128 v[112:115], v6 offset:4096
    ds_read_b128 v[116:119], v6 offset:6144
    ds_read_b64_tr_b16 v[136:137], v3 offset:0
    ds_read_b64_tr_b16 v[138:139], v3 offset:512
    ds_read_b64_tr_b16 v[140:141], v3 offset:4096
    ds_read_b64_tr_b16 v[142:143], v3 offset:4608
    ds_read_b64_tr_b16 v[144:145], v4 offset:0
    ds_read_b64_tr_b16 v[146:147], v4 offset:512
    s_waitcnt lgkmcnt(4)
L1_b:
    v_mfma_f32_16x16x32_bf16 v[8:11], v[136:139], v[104:107], v[8:11]
    ds_read_b64_tr_b16 v[148:149], v4 offset:4096
    v_mfma_f32_16x16x32_bf16 v[12:15], v[136:139], v[108:111], v[12:15]
    ds_read_b64_tr_b16 v[150:151], v4 offset:4608
    v_mfma_f32_16x16x32_bf16 v[16:19], v[136:139], v[112:115], v[16:19]
    s_barrier
    v_mfma_f32_16x16x32_bf16 v[20:23], v[136:139], v[116:119], v[20:23]
    s_waitcnt lgkmcnt(4)
    v_mfma_f32_16x16x32_bf16 v[36:39], v[140:143], v[116:119], v[36:39]
    ds_read_b128 v[120:123], v7 offset:0
    v_add_u32 v3, s60, v2
    v_mfma_f32_16x16x32_bf16 v[32:35], v[140:143], v[112:115], v[32:35]
    ds_read_b128 v[124:127], v7 offset:2048
    v_xor_b32 v4, 32, v3
    v_mfma_f32_16x16x32_bf16 v[28:31], v[140:143], v[108:111], v[28:31]
    ds_read_b128 v[128:131], v7 offset:4096
    v_mfma_f32_16x16x32_bf16 v[24:27], v[140:143], v[104:107], v[24:27]
    ds_read_b128 v[132:135], v7 offset:6144
    v_smfmac_f32_16x16x64_bf16 v[80:83], v[160:163], v[136:143], v94
    s_waitcnt lgkmcnt(6)
    v_mfma_f32_16x16x32_bf16 v[40:43], v[144:147], v[104:107], v[40:43]
    ds_read_b64_tr_b16 v[136:137], v3 offset:0
    s_add_u32 s60, s60, 12288
    v_mfma_f32_16x16x32_bf16 v[44:47], v[144:147], v[108:111], v[44:47]
    ds_read_b64_tr_b16 v[138:139], v3 offset:512
    s_cmp_eq_u32 s60, 159744
    v_mfma_f32_16x16x32_bf16 v[48:51], v[144:147], v[112:115], v[48:51]
    ds_read_b64_tr_b16 v[140:141], v3 offset:4096
    s_cselect_b32 s60, 98304, s60
    v_mfma_f32_16x16x32_bf16 v[52:55], v[144:147], v[116:119], v[52:55]
    ds_read_b64_tr_b16 v[142:143], v3 offset:4608
    s_waitcnt lgkmcnt(8)
    v_mfma_f32_16x16x32_bf16 v[68:71], v[148:151], v[116:119], v[68:71]
    ds_read_b64_tr_b16 v[144:145], v4 offset:0
    v_add_u32 v6, s61, v5
    v_mfma_f32_16x16x32_bf16 v[64:67], v[148:151], v[112:115], v[64:67]
    ds_read_b64_tr_b16 v[146:147], v4 offset:512
    v_xor_b32 v7, 64, v6
    v_mfma_f32_16x16x32_bf16 v[60:63], v[148:151], v[108:111], v[60:63]
    v_mfma_f32_16x16x32_bf16 v[56:59], v[148:151], v[104:107], v[56:59]
    s_waitcnt lgkmcnt(4)
    v_mfma_f32_16x16x32_bf16 v[8:11], v[136:139], v[120:123], v[8:11]
    ds_read_b64_tr_b16 v[148:149], v4 offset:4096
    v_mfma_f32_16x16x32_bf16 v[12:15], v[136:139], v[124:127], v[12:15]
    ds_read_b64_tr_b16 v[150:151], v4 offset:4608
    v_mfma_f32_16x16x32_bf16 v[16:19], v[136:139], v[128:131], v[16:19]
    s_barrier
    v_mfma_f32_16x16x32_bf16 v[20:23], v[136:139], v[132:135], v[20:23]
    s_waitcnt lgkmcnt(4)
    v_mfma_f32_16x16x32_bf16 v[36:39], v[140:143], v[132:135], v[36:39]
    ds_read_b128 v[104:107], v6 offset:0
    v_add_u32 v3, s60, v2
    v_mfma_f32_16x16x32_bf16 v[32:35], v[140:143], v[128:131], v[32:35]
    ds_read_b128 v[108:111], v6 offset:2048
    v_xor_b32 v4, 32, v3
    v_mfma_f32_16x16x32_bf16 v[28:31], v[140:143], v[124:127], v[28:31]
    ds_read_b128 v[112:115], v6 offset:4096
    v_mfma_f32_16x16x32_bf16 v[24:27], v[140:143], v[120:123], v[24:27]
    ds_read_b128 v[116:119], v6 offset:6144
    v_smfmac_f32_16x16x64_bf16 v[80:83], v[160:163], v[136:143], v94
    s_waitcnt lgkmcnt(6)
    v_mfma_f32_16x16x32_bf16 v[40:43], v[144:147], v[120:123], v[40:43]
    ds_read_b64_tr_b16 v[136:137], v3 offset:0
    s_add_u32 s60, s60, 12288
    v_mfma_f32_16x16x32_bf16 v[44:47], v[144:147], v[124:127], v[44:47]
    ds_read_b64_tr_b16 v[138:139], v3 offset:512
    s_cmp_eq_u32 s60, 159744
    v_mfma_f32_16x16x32_bf16 v[48:51], v[144:147], v[128:131], v[48:51]
    ds_read_b64_tr_b16 v[140:141], v3 offset:4096
    s_cselect_b32 s60, 98304, s60
    v_mfma_f32_16x16x32_bf16 v[52:55], v[144:147], v[132:135], v[52:55]
    ds_read_b64_tr_b16 v[142:143], v3 offset:4608
    s_waitcnt lgkmcnt(8)
    v_mfma_f32_16x16x32_bf16 v[68:71], v[148:151], v[132:135], v[68:71]
    ds_read_b64_tr_b16 v[144:145], v4 offset:0
    s_add_u32 s61, s61, 16384
    v_mfma_f32_16x16x32_bf16 v[64:67], v[148:151], v[128:131], v[64:67]
    ds_read_b64_tr_b16 v[146:147], v4 offset:512
    s_cmp_eq_u32 s61, 98304
    v_mfma_f32_16x16x32_bf16 v[60:63], v[148:151], v[124:127], v[60:63]
    s_cselect_b32 s61, 0, s61
    v_mfma_f32_16x16x32_bf16 v[56:59], v[148:151], v[120:123], v[56:59]
    s_waitcnt lgkmcnt(4)
    v_mfma_f32_16x16x32_bf16 v[8:11], v[136:139], v[104:107], v[8:11]
    ds_read_b64_tr_b16 v[148:149], v4 offset:4096
    v_mfma_f32_16x16x32_bf16 v[12:15], v[136:139], v[108:111], v[12:15]
    ds_read_b64_tr_b16 v[150:151], v4 offset:4608
    v_mfma_f32_16x16x32_bf16 v[16:19], v[136:139], v[112:115], v[16:19]
    s_barrier
    v_mfma_f32_16x16x32_bf16 v[20:23], v[136:139], v[116:119], v[20:23]
    s_waitcnt lgkmcnt(4)
    v_mfma_f32_16x16x32_bf16 v[36:39], v[140:143], v[116:119], v[36:39]
    ds_read_b128 v[120:123], v7 offset:0
    v_add_u32 v3, s60, v2
    v_mfma_f32_16x16x32_bf16 v[32:35], v[140:143], v[112:115], v[32:35]
    ds_read_b128 v[124:127], v7 offset:2048
    v_xor_b32 v4, 32, v3
    v_mfma_f32_16x16x32_bf16 v[28:31], v[140:143], v[108:111], v[28:31]
    ds_read_b128 v[128:131], v7 offset:4096
    v_mfma_f32_16x16x32_bf16 v[24:27], v[140:143], v[104:107], v[24:27]
    ds_read_b128 v[132:135], v7 offset:6144
    v_smfmac_f32_16x16x64_bf16 v[80:83], v[160:163], v[136:143], v94
    s_waitcnt lgkmcnt(6)
    v_mfma_f32_16x16x32_bf16 v[40:43], v[144:147], v[104:107], v[40:43]
    ds_read_b64_tr_b16 v[136:137], v3 offset:0
    s_add_u32 s60, s60, 12288
    v_mfma_f32_16x16x32_bf16 v[44:47], v[144:147], v[108:111], v[44:47]
    ds_read_b64_tr_b16 v[138:139], v3 offset:512
    s_cmp_eq_u32 s60, 159744
    v_mfma_f32_16x16x32_bf16 v[48:51], v[144:147], v[112:115], v[48:51]
    ds_read_b64_tr_b16 v[140:141], v3 offset:4096
    s_cselect_b32 s60, 98304, s60
    v_mfma_f32_16x16x32_bf16 v[52:55], v[144:147], v[116:119], v[52:55]
    ds_read_b64_tr_b16 v[142:143], v3 offset:4608
    s_waitcnt lgkmcnt(8)
    v_mfma_f32_16x16x32_bf16 v[68:71], v[148:151], v[116:119], v[68:71]
    ds_read_b64_tr_b16 v[144:145], v4 offset:0
    v_add_u32 v6, s61, v5
    v_mfma_f32_16x16x32_bf16 v[64:67], v[148:151], v[112:115], v[64:67]
    ds_read_b64_tr_b16 v[146:147], v4 offset:512
    v_xor_b32 v7, 64, v6
    v_mfma_f32_16x16x32_bf16 v[60:63], v[148:151], v[108:111], v[60:63]
    v_mfma_f32_16x16x32_bf16 v[56:59], v[148:151], v[104:107], v[56:59]
    s_waitcnt lgkmcnt(4)
    v_mfma_f32_16x16x32_bf16 v[8:11], v[136:139], v[120:123], v[8:11]
    ds_read_b64_tr_b16 v[148:149], v4 offset:4096
    v_mfma_f32_16x16x32_bf16 v[12:15], v[136:139], v[124:127], v[12:15]
    ds_read_b64_tr_b16 v[150:151], v4 offset:4608
    v_mfma_f32_16x16x32_bf16 v[16:19], v[136:139], v[128:131], v[16:19]
    s_barrier
    v_mfma_f32_16x16x32_bf16 v[20:23], v[136:139], v[132:135], v[20:23]
    s_waitcnt lgkmcnt(4)
    v_mfma_f32_16x16x32_bf16 v[36:39], v[140:143], v[132:135], v[36:39]
    ds_read_b128 v[104:107], v6 offset:0
    v_add_u32 v3, s60, v2
    v_mfma_f32_16x16x32_bf16 v[32:35], v[140:143], v[128:131], v[32:35]
    ds_read_b128 v[108:111], v6 offset:2048
    v_xor_b32 v4, 32, v3
    v_mfma_f32_16x16x32_bf16 v[28:31], v[140:143], v[124:127], v[28:31]
    ds_read_b128 v[112:115], v6 offset:4096
    s_sub_u32 s62, s62, 1
    v_mfma_f32_16x16x32_bf16 v[24:27], v[140:143], v[120:123], v[24:27]
    ds_read_b128 v[116:119], v6 offset:6144
    v_smfmac_f32_16x16x64_bf16 v[80:83], v[160:163], v[136:143], v94
    s_waitcnt lgkmcnt(6)
    v_mfma_f32_16x16x32_bf16 v[40:43], v[144:147], v[120:123], v[40:43]
    ds_read_b64_tr_b16 v[136:137], v3 offset:0
    s_add_u32 s60, s60, 12288
    v_mfma_f32_16x16x32_bf16 v[44:47], v[144:147], v[124:127], v[44:47]
    ds_read_b64_tr_b16 v[138:139], v3 offset:512
    s_cmp_eq_u32 s60, 159744
    v_mfma_f32_16x16x32_bf16 v[48:51], v[144:147], v[128:131], v[48:51]
    ds_read_b64_tr_b16 v[140:141], v3 offset:4096
    s_cselect_b32 s60, 98304, s60
    v_mfma_f32_16x16x32_bf16 v[52:55], v[144:147], v[132:135], v[52:55]
    ds_read_b64_tr_b16 v[142:143], v3 offset:4608
    s_waitcnt lgkmcnt(8)
    v_mfma_f32_16x16x32_bf16 v[68:71], v[148:151], v[132:135], v[68:71]
    ds_read_b64_tr_b16 v[144:145], v4 offset:0
    s_add_u32 s61, s61, 16384
    v_mfma_f32_16x16x32_bf16 v[64:67], v[148:151], v[128:131], v[64:67]
    ds_read_b64_tr_b16 v[146:147], v4 offset:512
    s_cmp_eq_u32 s61, 98304
    v_mfma_f32_16x16x32_bf16 v[60:63], v[148:151], v[124:127], v[60:63]
    s_cselect_b32 s61, 0, s61
    s_cmp_lg_u32 s62, 0
    v_mfma_f32_16x16x32_bf16 v[56:59], v[148:151], v[120:123], v[56:59]
    s_waitcnt lgkmcnt(4)
    s_cbranch_scc1 L1_b
    s_waitcnt lgkmcnt(0)
    v_add_f32 v124, v80, v81
    v_add_f32 v125, v82, v83
    v_mov_b32 v126, v164
    v_xor_b32 v127, 64, v166
    s_mov_b64 exec, 0xffff
    ds_write_b32 v93, v124 offset:0
    ds_write_b32 v93, v125 offset:256
    s_mov_b64 exec, 1
    v_mov_b32 v128, 1
    ds_add_u32 v126, v128 offset:28
    s_mov_b64 exec, -1
    ds_read_b128 v[80:83], v166 offset:0
    ds_read_b128 v[84:87], v166 offset:256
    s_waitcnt vmcnt(0)
    v_lshlrev_b32 v2, 4, v0
    v_mov_b32 v104, v153
    v_mov_b32 v105, v153
    v_mov_b32 v106, v153
    v_mov_b32 v107, v153
    v_mov_b32 v108, v153
    v_mov_b32 v109, v153
    v_mov_b32 v110, v153
    v_mov_b32 v111, v153
    v_mov_b32 v112, v153
    v_mov_b32 v113, v153
    v_mov_b32 v114, v153
    v_mov_b32 v115, v153
    v_mov_b32 v4, v152
    v_lshl_add_u32 v3, s8, 3, v2
    v_mov_b32 v5, v2
    v_add_u32 v7, 12288, v152
    v_mov_b32 v6, v3
    s_waitcnt lgkmcnt(0)
    v_pk_fma_f32 v[8:9], v[80:81], v[72:73], v[8:9] op_sel_hi:[1,0,1]
    v_pk_fma_f32 v[10:11], v[82:83], v[72:73], v[10:11] op_sel_hi:[1,0,1]
    v_pk_fma_f32 v[12:13], v[80:81], v[74:75], v[12:13] op_sel_hi:[1,0,1]
    v_pk_fma_f32 v[14:15], v[82:83], v[74:75], v[14:15] op_sel_hi:[1,0,1]
    v_pk_fma_f32 v[16:17], v[80:81], v[76:77], v[16:17] op_sel_hi:[1,0,1]
    v_pk_fma_f32 v[18:19], v[82:83], v[76:77], v[18:19] op_sel_hi:[1,0,1]
    v_pk_fma_f32 v[20:21], v[80:81], v[78:79], v[20:21] op_sel_hi:[1,0,1]
    v_pk_fma_f32 v[22:23], v[82:83], v[78:79], v[22:23] op_sel_hi:[1,0,1]
    v_pk_fma_f32 v[24:25], v[84:85], v[72:73], v[24:25] op_sel_hi:[1,0,1]
    v_pk_fma_f32 v[26:27], v[86:87], v[72:73], v[26:27] op_sel_hi:[1,0,1]
    v_pk_fma_f32 v[28:29], v[84:85], v[74:75], v[28:29] op_sel_hi:[1,0,1]
    v_pk_fma_f32 v[30:31], v[86:87], v[74:75], v[30:31] op_sel_hi:[1,0,1]
    v_pk_fma_f32 v[32:33], v[84:85], v[76:77], v[32:33] op_sel_hi:[1,0,1]
    v_pk_fma_f32 v[34:35], v[86:87], v[76:77], v[34:35] op_sel_hi:[1,0,1]
    v_pk_fma_f32 v[36:37], v[84:85], v[78:79], v[36:37] op_sel_hi:[1,0,1]
    v_pk_fma_f32 v[38:39], v[86:87], v[78:79], v[38:39] op_sel_hi:[1,0,1]
    v_pk_mul_f32 v[116:117], v[8:9], v[96:97] op_sel_hi:[1,0]
    v_pk_mul_f32 v[118:119], v[10:11], v[96:97] op_sel_hi:[1,0]
    v_pk_mul_f32 v[120:121], v[12:13], v[98:99] op_sel_hi:[1,0]
    v_pk_mul_f32 v[122:123], v[14:15], v[98:99] op_sel_hi:[1,0]
    v_exp_f32 v116, v116
    v_exp_f32 v117, v117
    v_exp_f32 v118, v118
    v_exp_f32 v119, v119
    v_exp_f32 v120, v120
    v_exp_f32 v121, v121
    v_exp_f32 v122, v122
    v_exp_f32 v123, v123
    v_pk_mul_f32 v[8:9], v[8:9], v[24:25]
    v_pk_mul_f32 v[10:11], v[10:11], v[26:27]
    v_pk_mul_f32 v[12:13], v[12:13], v[28:29]
    v_pk_mul_f32 v[14:15], v[14:15], v[30:31]
    v_pk_fma_f32 v[116:117], v[116:117], v[96:97], v[96:97] op_sel:[0,1,1]
    v_pk_fma_f32 v[118:119], v[118:119], v[96:97], v[96:97] op_sel:[0,1,1]
    v_pk_fma_f32 v[120:121], v[120:121], v[98:99], v[98:99] op_sel:[0,1,1]
    v_pk_fma_f32 v[122:123], v[122:123], v[98:99], v[98:99] op_sel:[0,1,1]
    v_rcp_f32 v116, v116
    v_rcp_f32 v117, v117
    v_rcp_f32 v118, v118
    v_rcp_f32 v119, v119
    v_rcp_f32 v120, v120
    v_rcp_f32 v121, v121
    v_rcp_f32 v122, v122
    v_rcp_f32 v123, v123
    v_pk_mul_f32 v[8:9], v[8:9], v[116:117]
    v_pk_mul_f32 v[10:11], v[10:11], v[118:119]
    v_pk_mul_f32 v[12:13], v[12:13], v[120:121]
    v_pk_mul_f32 v[14:15], v[14:15], v[122:123]
    v_cvt_pk_bf16_f32 v152, v8, v9
    v_cvt_pk_bf16_f32 v153, v10, v11
    v_cvt_pk_bf16_f32 v154, v12, v13
    v_cvt_pk_bf16_f32 v155, v14, v15
    ds_read_b32 v128, v126 offset:28
    v_pk_mul_f32 v[116:117], v[16:17], v[100:101] op_sel_hi:[1,0]
    v_pk_mul_f32 v[118:119], v[18:19], v[100:101] op_sel_hi:[1,0]
    v_pk_mul_f32 v[120:121], v[20:21], v[102:103] op_sel_hi:[1,0]
    v_pk_mul_f32 v[122:123], v[22:23], v[102:103] op_sel_hi:[1,0]
    v_exp_f32 v116, v116
    v_exp_f32 v117, v117
    v_exp_f32 v118, v118
    v_exp_f32 v119, v119
    v_exp_f32 v120, v120
    v_exp_f32 v121, v121
    v_exp_f32 v122, v122
    v_exp_f32 v123, v123
    v_pk_mul_f32 v[16:17], v[16:17], v[32:33]
    v_pk_mul_f32 v[18:19], v[18:19], v[34:35]
    v_pk_mul_f32 v[20:21], v[20:21], v[36:37]
    v_pk_mul_f32 v[22:23], v[22:23], v[38:39]
    v_pk_fma_f32 v[116:117], v[116:117], v[100:101], v[100:101] op_sel:[0,1,1]
    v_pk_fma_f32 v[118:119], v[118:119], v[100:101], v[100:101] op_sel:[0,1,1]
    v_pk_fma_f32 v[120:121], v[120:121], v[102:103], v[102:103] op_sel:[0,1,1]
    v_pk_fma_f32 v[122:123], v[122:123], v[102:103], v[102:103] op_sel:[0,1,1]
    s_waitcnt lgkmcnt(0)
    v_cmp_gt_u32 vcc, 4, v128
    v_rcp_f32 v116, v116
    v_rcp_f32 v117, v117
    v_rcp_f32 v118, v118
    v_rcp_f32 v119, v119
    v_rcp_f32 v120, v120
    v_rcp_f32 v121, v121
    v_rcp_f32 v122, v122
    v_rcp_f32 v123, v123
    s_cbranch_vccnz L1_csw
L1_csr:
    ds_read_b128 v[88:91], v127 offset:0
    ds_read_b128 v[92:95], v127 offset:256
    v_pk_mul_f32 v[16:17], v[16:17], v[116:117]
    v_pk_mul_f32 v[18:19], v[18:19], v[118:119]
    v_pk_mul_f32 v[20:21], v[20:21], v[120:121]
    v_pk_mul_f32 v[22:23], v[22:23], v[122:123]
    v_cvt_pk_bf16_f32 v156, v16, v17
    v_cvt_pk_bf16_f32 v157, v18, v19
    v_cvt_pk_bf16_f32 v158, v20, v21
    v_cvt_pk_bf16_f32 v159, v22, v23
    s_nop 0
    v_permlane16_swap_b32 v152, v154
    v_permlane16_swap_b32 v153, v155
    v_permlane16_swap_b32 v156, v158
    v_permlane16_swap_b32 v157, v159
    buffer_store_dwordx4 v[152:155], v2, s[24:27], s68 offen sc1
    s_add_u32 s68, s68, 98304
    buffer_store_dwordx4 v[156:159], v2, s[24:27], s68 offen sc1
    s_waitcnt lgkmcnt(0)
    v_pk_fma_f32 v[40:41], v[88:89], v[72:73], v[40:41] op_sel_hi:[1,0,1]
    v_pk_fma_f32 v[42:43], v[90:91], v[72:73], v[42:43] op_sel_hi:[1,0,1]
    v_pk_fma_f32 v[44:45], v[88:89], v[74:75], v[44:45] op_sel_hi:[1,0,1]
    v_pk_fma_f32 v[46:47], v[90:91], v[74:75], v[46:47] op_sel_hi:[1,0,1]
    v_pk_fma_f32 v[48:49], v[88:89], v[76:77], v[48:49] op_sel_hi:[1,0,1]
    v_pk_fma_f32 v[50:51], v[90:91], v[76:77], v[50:51] op_sel_hi:[1,0,1]
    v_pk_fma_f32 v[52:53], v[88:89], v[78:79], v[52:53] op_sel_hi:[1,0,1]
    v_pk_fma_f32 v[54:55], v[90:91], v[78:79], v[54:55] op_sel_hi:[1,0,1]
    v_pk_fma_f32 v[56:57], v[92:93], v[72:73], v[56:57] op_sel_hi:[1,0,1]
    v_pk_fma_f32 v[58:59], v[94:95], v[72:73], v[58:59] op_sel_hi:[1,0,1]
    v_pk_fma_f32 v[60:61], v[92:93], v[74:75], v[60:61] op_sel_hi:[1,0,1]
    v_pk_fma_f32 v[62:63], v[94:95], v[74:75], v[62:63] op_sel_hi:[1,0,1]
    v_pk_fma_f32 v[64:65], v[92:93], v[76:77], v[64:65] op_sel_hi:[1,0,1]
    v_pk_fma_f32 v[66:67], v[94:95], v[76:77], v[66:67] op_sel_hi:[1,0,1]
    v_pk_fma_f32 v[68:69], v[92:93], v[78:79], v[68:69] op_sel_hi:[1,0,1]
    v_pk_fma_f32 v[70:71], v[94:95], v[78:79], v[70:71] op_sel_hi:[1,0,1]
    v_pk_mul_f32 v[116:117], v[40:41], v[96:97] op_sel_hi:[1,0]
    v_pk_mul_f32 v[118:119], v[42:43], v[96:97] op_sel_hi:[1,0]
    v_pk_mul_f32 v[120:121], v[44:45], v[98:99] op_sel_hi:[1,0]
    v_pk_mul_f32 v[122:123], v[46:47], v[98:99] op_sel_hi:[1,0]
    v_exp_f32 v116, v116
    v_exp_f32 v117, v117
    v_exp_f32 v118, v118
    v_exp_f32 v119, v119
    v_exp_f32 v120, v120
    v_exp_f32 v121, v121
    v_exp_f32 v122, v122
    v_exp_f32 v123, v123
    v_pk_mul_f32 v[40:41], v[40:41], v[56:57]
    v_pk_mul_f32 v[42:43], v[42:43], v[58:59]
    v_pk_mul_f32 v[44:45], v[44:45], v[60:61]
    v_pk_mul_f32 v[46:47], v[46:47], v[62:63]
    v_pk_fma_f32 v[116:117], v[116:117], v[96:97], v[96:97] op_sel:[0,1,1]
    v_pk_fma_f32 v[118:119], v[118:119], v[96:97], v[96:97] op_sel:[0,1,1]
    v_pk_fma_f32 v[120:121], v[120:121], v[98:99], v[98:99] op_sel:[0,1,1]
    v_pk_fma_f32 v[122:123], v[122:123], v[98:99], v[98:99] op_sel:[0,1,1]
    v_rcp_f32 v116, v116
    v_rcp_f32 v117, v117
    v_rcp_f32 v118, v118
    v_rcp_f32 v119, v119
    v_rcp_f32 v120, v120
    v_rcp_f32 v121, v121
    v_rcp_f32 v122, v122
    v_rcp_f32 v123, v123
    v_pk_mul_f32 v[40:41], v[40:41], v[116:117]
    v_pk_mul_f32 v[42:43], v[42:43], v[118:119]
    v_pk_mul_f32 v[44:45], v[44:45], v[120:121]
    v_pk_mul_f32 v[46:47], v[46:47], v[122:123]
    v_cvt_pk_bf16_f32 v160, v40, v41
    v_cvt_pk_bf16_f32 v161, v42, v43
    v_cvt_pk_bf16_f32 v162, v44, v45
    v_cvt_pk_bf16_f32 v163, v46, v47
    v_pk_mul_f32 v[116:117], v[48:49], v[100:101] op_sel_hi:[1,0]
    v_pk_mul_f32 v[118:119], v[50:51], v[100:101] op_sel_hi:[1,0]
    v_pk_mul_f32 v[120:121], v[52:53], v[102:103] op_sel_hi:[1,0]
    v_pk_mul_f32 v[122:123], v[54:55], v[102:103] op_sel_hi:[1,0]
    v_exp_f32 v116, v116
    v_exp_f32 v117, v117
    v_exp_f32 v118, v118
    v_exp_f32 v119, v119
    v_exp_f32 v120, v120
    v_exp_f32 v121, v121
    v_exp_f32 v122, v122
    v_exp_f32 v123, v123
    v_pk_mul_f32 v[48:49], v[48:49], v[64:65]
    v_pk_mul_f32 v[50:51], v[50:51], v[66:67]
    v_pk_mul_f32 v[52:53], v[52:53], v[68:69]
    v_pk_mul_f32 v[54:55], v[54:55], v[70:71]
    v_pk_fma_f32 v[116:117], v[116:117], v[100:101], v[100:101] op_sel:[0,1,1]
    v_pk_fma_f32 v[118:119], v[118:119], v[100:101], v[100:101] op_sel:[0,1,1]
    v_pk_fma_f32 v[120:121], v[120:121], v[102:103], v[102:103] op_sel:[0,1,1]
    v_pk_fma_f32 v[122:123], v[122:123], v[102:103], v[102:103] op_sel:[0,1,1]
    v_rcp_f32 v116, v116
    v_rcp_f32 v117, v117
    v_rcp_f32 v118, v118
    v_rcp_f32 v119, v119
    v_rcp_f32 v120, v120
    v_rcp_f32 v121, v121
    v_rcp_f32 v122, v122
    v_rcp_f32 v123, v123
    v_pk_mul_f32 v[48:49], v[48:49], v[116:117]
    v_pk_mul_f32 v[50:51], v[50:51], v[118:119]
    v_pk_mul_f32 v[52:53], v[52:53], v[120:121]
    v_pk_mul_f32 v[54:55], v[54:55], v[122:123]
    v_cvt_pk_bf16_f32 v164, v48, v49
    v_cvt_pk_bf16_f32 v165, v50, v51
    v_cvt_pk_bf16_f32 v166, v52, v53
    v_cvt_pk_bf16_f32 v167, v54, v55
    s_nop 0
    v_permlane16_swap_b32 v160, v162
    v_permlane16_swap_b32 v161, v163
    v_permlane16_swap_b32 v164, v166
    v_permlane16_swap_b32 v165, v167
    buffer_store_dwordx4 v[160:163], v2, s[24:27], s69 offen sc1
    s_add_u32 s69, s69, 98304
    buffer_store_dwordx4 v[164:167], v2, s[24:27], s69 offen sc1
    v_mov_b32 v40, 0
    v_mov_b32 v41, 0
    v_mov_b32 v42, 0
    v_mov_b32 v43, 0
    v_mov_b32 v44, 0
    v_mov_b32 v45, 0
    v_mov_b32 v46, 0
    v_mov_b32 v47, 0
    v_cmp_gt_u32 vcc, 32, v0
    v_mov_b32 v87, 0xdddddddd
    v_and_b32 v8, 0x1ff, v3
    v_mfma_f32_32x32x16_bf16 v[48:63], v[40:43], v[40:43], 0
    v_add_u32 v10, s45, v2
    v_add_u32 v11, s47, v8
    v_mov_b32 v9, 0xff800000
L2_attn:
    s_barrier
    ds_read_b64 v[92:93], v11 offset:47104
    ds_read_b128 v[88:91], v10 offset:45056
    ds_read_b128 v[96:99], v5 offset:0
    ds_read_b64 v[100:101], v6 offset:2048
    s_waitcnt lgkmcnt(0)
    v_cndmask_b32 v94, v92, v40, vcc
    v_cndmask_b32 v95, v93, v40, vcc
    v_cndmask_b32 v92, 0, v92, vcc
    v_cndmask_b32 v93, 0, v93, vcc
    v_mfma_f32_32x32x16_bf16 v[16:31], v[96:99], v[88:91], 0
    ds_read_b128 v[96:99], v5 offset:1024
    v_mfma_f32_32x32x8_bf16 v[16:31], v[100:101], v[92:93], v[16:31]
    s_mov_b64 exec, s[4:5]
    ds_read_b128 v[104:107], v7 offset:0
    ds_read_b128 v[108:111], v7 offset:320
    s_mov_b64 exec, -1
    s_nop 7
    v_max3_f32 v10, v16, v17, v18
    v_max3_f32 v11, v19, v20, v21
    v_max3_f32 v10, v10, v22, v23
    v_max3_f32 v11, v11, v24, v25
    v_max3_f32 v10, v10, v26, v27
    v_max3_f32 v11, v11, v28, v29
    v_max3_f32 v10, v10, v30, v31
    v_max3_f32 v9, v10, v11, v9
    v_mov_b32 v10, v9
    s_nop 1
    v_permlane32_swap_b32 v10, v9
    s_nop 0
    v_max_f32 v9, v10, v9
    v_sub_f32 v64, 0, v9
    v_sub_f32 v65, 0, v9
    v_sub_f32 v66, 0, v9
    v_sub_f32 v67, 0, v9
    v_sub_f32 v68, 0, v9
    v_sub_f32 v69, 0, v9
    v_sub_f32 v70, 0, v9
    v_sub_f32 v71, 0, v9
    v_sub_f32 v72, 0, v9
    v_sub_f32 v73, 0, v9
    v_sub_f32 v74, 0, v9
    v_sub_f32 v75, 0, v9
    v_sub_f32 v76, 0, v9
    v_sub_f32 v77, 0, v9
    v_sub_f32 v78, 0, v9
    v_sub_f32 v79, 0, v9
    v_sub_f32 v16, v16, v9
    v_sub_f32 v17, v17, v9
    v_sub_f32 v18, v18, v9
    v_sub_f32 v19, v19, v9
    v_sub_f32 v20, v20, v9
    v_sub_f32 v21, v21, v9
    v_sub_f32 v22, v22, v9
    v_sub_f32 v23, v23, v9
    v_sub_f32 v24, v24, v9
    v_sub_f32 v25, v25, v9
    v_sub_f32 v26, v26, v9
    v_sub_f32 v27, v27, v9
    v_sub_f32 v28, v28, v9
    v_sub_f32 v29, v29, v9
    v_sub_f32 v30, v30, v9
    v_sub_f32 v31, v31, v9
    s_branch L2_entry
L2_pre7:
    s_lshl_b32 s11, s3, 6
    v_add_u32 v1, s11, v0
    v_mul_u32_u24 v10, 3277, v1
    v_lshrrev_b32 v10, 16, v10
    v_mul_u32_u24 v11, 20, v10
    v_sub_u32 v11, v1, v11
    v_mul_u32_u24 v1, 1280, v10
    v_lshl_add_u32 v1, v11, 4, v1
    buffer_load_dwordx4 v[12:15], v1, s[28:31], s17 offen
    s_branch L2_nopre
L2_pre5:
    s_add_u32 s11, s15, 0
    buffer_load_dwordx4 v[120:123], v2, s[24:27], s11 offen sc1
    s_add_u32 s11, s15, 81920
    buffer_load_dwordx4 v[124:127], v2, s[24:27], s11 offen sc1
    s_add_u32 s11, s15, 1024
    buffer_load_dwordx4 v[128:131], v2, s[24:27], s11 offen sc1
    s_branch L2_nopre
L2_pre4:
    s_add_u32 s11, s15, 82944
    buffer_load_dwordx4 v[132:135], v2, s[24:27], s11 offen sc1
    s_add_u32 s11, s15, 2048
    buffer_load_dwordx4 v[136:139], v2, s[24:27], s11 offen sc1
    s_add_u32 s11, s15, 83968
    buffer_load_dwordx4 v[140:143], v2, s[24:27], s11 offen sc1
    s_branch L2_nopre
L2_pre3:
    s_add_u32 s11, s15, 3072
    buffer_load_dwordx4 v[144:147], v2, s[24:27], s11 offen sc1
    s_add_u32 s11, s15, 84992
    buffer_load_dwordx4 v[148:151], v2, s[24:27], s11 offen sc1
    s_branch L2_nopre
L2_pre2:
    s_add_u32 s11, s15, 4096
    buffer_load_dwordx4 v[152:155], v2, s[24:27], s11 offen sc1
    s_add_u32 s11, s15, 86016
    buffer_load_dwordx4 v[156:159], v2, s[24:27], s11 offen sc1
    s_branch L2_nopre
L2_pre1:
    s_add_u32 s11, s15, 5120
    buffer_load_dwordx4 v[160:163], v2, s[24:27], s11 offen sc1
    s_add_u32 s11, s15, 87040
    buffer_load_dwordx4 v[164:167], v2, s[24:27], s11 offen sc1
    s_branch L2_nopre
L2_entry:
    s_setprio 2
    v_exp_f32 v16, v16
    v_exp_f32 v17, v17
    v_smfmac_f32_32x32x32_bf16 v[48:63], v[112:115], v[40:47], v87
    v_exp_f32 v18, v18
    v_exp_f32 v19, v19
    v_exp_f32 v20, v20
    v_mfma_f32_32x32x8_bf16 v[32:47], v[100:101], v[94:95], v[64:79]
    ds_read_b64 v[100:101], v6 offset:5120
    v_exp_f32 v21, v21
    v_exp_f32 v22, v22
    v_exp_f32 v23, v23
    v_exp_f32 v24, v24
    v_exp_f32 v25, v25
    s_waitcnt lgkmcnt(1)
    v_mfma_f32_32x32x16_bf16 v[32:47], v[96:99], v[88:91], v[32:47]
    ds_read_b128 v[96:99], v5 offset:3072
    v_exp_f32 v26, v26
    v_exp_f32 v27, v27
    v_exp_f32 v28, v28
    v_exp_f32 v29, v29
    v_smfmac_f32_32x32x32_bf16 v[48:63], v[104:107], v[16:23], v87
    s_mov_b64 exec, s[4:5]
    ds_read_b128 v[104:107], v7 offset:1280
    ds_read_b128 v[112:115], v7 offset:1600
    s_mov_b64 exec, -1
    v_exp_f32 v30, v30
    v_exp_f32 v31, v31
    s_cmp_eq_u32 s44, 7
    s_cbranch_scc1 L2_pre7
    s_cmp_eq_u32 s44, 5
    s_cbranch_scc1 L2_pre5
    s_cmp_eq_u32 s44, 4
    s_cbranch_scc1 L2_pre4
    s_cmp_eq_u32 s44, 3
    s_cbranch_scc1 L2_pre3
    s_cmp_eq_u32 s44, 2
    s_cbranch_scc1 L2_pre2
    s_cmp_eq_u32 s44, 1
    s_cbranch_scc1 L2_pre1
L2_nopre:
    v_exp_f32 v32, v32
    v_exp_f32 v33, v33
    v_smfmac_f32_32x32x32_bf16 v[48:63], v[108:111], v[24:31], v87
    v_exp_f32 v34, v34
    v_exp_f32 v35, v35
    v_exp_f32 v36, v36
    s_waitcnt lgkmcnt(3)
    v_mfma_f32_32x32x8_bf16 v[16:31], v[100:101], v[92:93], v[64:79]
    v_exp_f32 v37, v37
    v_exp_f32 v38, v38
    v_exp_f32 v39, v39
    v_exp_f32 v40, v40
    v_exp_f32 v41, v41
    s_waitcnt lgkmcnt(0)
    v_mfma_f32_32x32x16_bf16 v[16:31], v[96:99], v[88:91], v[16:31]
    ds_read_b128 v[96:99], v5 offset:4096
    v_exp_f32 v42, v42
    v_exp_f32 v43, v43
    v_exp_f32 v44, v44
    v_exp_f32 v45, v45
    v_smfmac_f32_32x32x32_bf16 v[48:63], v[104:107], v[32:39], v87
    s_mov_b64 exec, s[4:5]
    ds_read_b128 v[104:107], v7 offset:2560
    ds_read_b128 v[108:111], v7 offset:2880
    s_mov_b64 exec, -1
    v_exp_f32 v46, v46
    v_exp_f32 v47, v47
    v_exp_f32 v16, v16
    v_exp_f32 v17, v17
    v_smfmac_f32_32x32x32_bf16 v[48:63], v[112:115], v[40:47], v87
    v_exp_f32 v18, v18
    v_exp_f32 v19, v19
    v_exp_f32 v20, v20
    v_mfma_f32_32x32x8_bf16 v[32:47], v[100:101], v[94:95], v[64:79]
    ds_read_b64 v[100:101], v6 offset:8192
    v_exp_f32 v21, v21
    v_exp_f32 v22, v22
    v_exp_f32 v23, v23
    v_exp_f32 v24, v24
    v_exp_f32 v25, v25
    s_waitcnt lgkmcnt(1)
    v_mfma_f32_32x32x16_bf16 v[32:47], v[96:99], v[88:91], v[32:47]
    ds_read_b128 v[96:99], v5 offset:6144
    v_exp_f32 v26, v26
    v_exp_f32 v27, v27
    v_exp_f32 v28, v28
    v_exp_f32 v29, v29
    v_smfmac_f32_32x32x32_bf16 v[48:63], v[104:107], v[16:23], v87
    s_mov_b64 exec, s[4:5]
    ds_read_b128 v[104:107], v7 offset:3840
    ds_read_b128 v[112:115], v7 offset:4160
    s_mov_b64 exec, -1
    v_exp_f32 v30, v30
    v_exp_f32 v31, v31
    v_exp_f32 v32, v32
    v_exp_f32 v33, v33
    v_smfmac_f32_32x32x32_bf16 v[48:63], v[108:111], v[24:31], v87
    v_exp_f32 v34, v34
    v_exp_f32 v35, v35
    v_exp_f32 v36, v36
    s_waitcnt lgkmcnt(3)
    v_mfma_f32_32x32x8_bf16 v[16:31], v[100:101], v[92:93], v[64:79]
    v_exp_f32 v37, v37
    v_exp_f32 v38, v38
    v_exp_f32 v39, v39
    v_exp_f32 v40, v40
    v_exp_f32 v41, v41
    s_waitcnt lgkmcnt(0)
    v_mfma_f32_32x32x16_bf16 v[16:31], v[96:99], v[88:91], v[16:31]
    ds_read_b128 v[96:99], v5 offset:7168
    v_exp_f32 v42, v42
    v_exp_f32 v43, v43
    v_exp_f32 v44, v44
    v_exp_f32 v45, v45
    v_smfmac_f32_32x32x32_bf16 v[48:63], v[104:107], v[32:39], v87
    s_mov_b64 exec, s[4:5]
    ds_read_b128 v[104:107], v7 offset:5120
    ds_read_b128 v[108:111], v7 offset:5440
    s_mov_b64 exec, -1
    v_exp_f32 v46, v46
    v_exp_f32 v47, v47
    s_setprio 1
    v_exp_f32 v16, v16
    v_exp_f32 v17, v17
    v_smfmac_f32_32x32x32_bf16 v[48:63], v[112:115], v[40:47], v87
    v_exp_f32 v18, v18
    v_exp_f32 v19, v19
    v_exp_f32 v20, v20
    v_mfma_f32_32x32x8_bf16 v[32:47], v[100:101], v[94:95], v[64:79]
    ds_read_b64 v[100:101], v6 offset:11264
    v_exp_f32 v21, v21
    v_exp_f32 v22, v22
    v_exp_f32 v23, v23
    v_exp_f32 v24, v24
    v_exp_f32 v25, v25
    s_waitcnt lgkmcnt(1)
    v_mfma_f32_32x32x16_bf16 v[32:47], v[96:99], v[88:91], v[32:47]
    ds_read_b128 v[96:99], v5 offset:9216
    s_add_u32 s19, s19, 22528
    s_cmp_eq_u32 s19, 67584
    s_cselect_b32 s19, 0, s19
    s_add_u32 s45, s19, 12288
    v_add_u32 v6, s19, v3
    v_exp_f32 v26, v26
    v_exp_f32 v27, v27
    v_exp_f32 v28, v28
    v_exp_f32 v29, v29
    v_smfmac_f32_32x32x32_bf16 v[48:63], v[104:107], v[16:23], v87
    s_mov_b64 exec, s[4:5]
    ds_read_b128 v[104:107], v7 offset:6400
    ds_read_b128 v[112:115], v7 offset:6720
    s_mov_b64 exec, -1
    v_exp_f32 v30, v30
    v_exp_f32 v31, v31
    s_setprio 0
    v_exp_f32 v32, v32
    v_exp_f32 v33, v33
    v_smfmac_f32_32x32x32_bf16 v[48:63], v[108:111], v[24:31], v87
    v_exp_f32 v34, v34
    v_exp_f32 v35, v35
    v_exp_f32 v36, v36
    s_waitcnt lgkmcnt(3)
    v_mfma_f32_32x32x8_bf16 v[16:31], v[100:101], v[92:93], v[64:79]
    v_exp_f32 v37, v37
    v_exp_f32 v38, v38
    v_exp_f32 v39, v39
    v_exp_f32 v40, v40
    v_exp_f32 v41, v41
    s_waitcnt lgkmcnt(0)
    v_mfma_f32_32x32x16_bf16 v[16:31], v[96:99], v[88:91], v[16:31]
    ds_read_b128 v[96:99], v5 offset:10240
    v_add_u32 v5, s19, v2
    v_exp_f32 v42, v42
    v_exp_f32 v43, v43
    v_exp_f32 v44, v44
    v_exp_f32 v45, v45
    v_smfmac_f32_32x32x32_bf16 v[48:63], v[104:107], v[32:39], v87
    s_mov_b64 exec, s[4:5]
    ds_read_b128 v[104:107], v7 offset:7680
    ds_read_b128 v[108:111], v7 offset:8000
    s_mov_b64 exec, -1
    v_exp_f32 v46, v46
    v_exp_f32 v47, v47
    s_waitcnt vmcnt(0)
    s_barrier
    s_setprio 2
    v_exp_f32 v16, v16
    v_exp_f32 v17, v17
    v_smfmac_f32_32x32x32_bf16 v[48:63], v[112:115], v[40:47], v87
    v_exp_f32 v18, v18
    v_exp_f32 v19, v19
    v_exp_f32 v20, v20
    v_mfma_f32_32x32x8_bf16 v[32:47], v[100:101], v[94:95], v[64:79]
    ds_read_b64 v[100:101], v6 offset:2048
    v_exp_f32 v21, v21
    v_exp_f32 v22, v22
    v_exp_f32 v23, v23
    v_exp_f32 v24, v24
    v_exp_f32 v25, v25
    s_waitcnt lgkmcnt(1)
    v_mfma_f32_32x32x16_bf16 v[32:47], v[96:99], v[88:91], v[32:47]
    ds_read_b128 v[96:99], v5 offset:0
    v_exp_f32 v26, v26
    v_exp_f32 v27, v27
    v_exp_f32 v28, v28
    v_exp_f32 v29, v29
    v_smfmac_f32_32x32x32_bf16 v[48:63], v[104:107], v[16:23], v87
    s_mov_b64 exec, s[4:5]
    ds_read_b128 v[104:107], v7 offset:8960
    ds_read_b128 v[112:115], v7 offset:9280
    s_mov_b64 exec, -1
    v_add_u32 v7, s45, v4
    v_exp_f32 v30, v30
    v_exp_f32 v31, v31
    v_exp_f32 v32, v32
    v_exp_f32 v33, v33
    v_smfmac_f32_32x32x32_bf16 v[48:63], v[108:111], v[24:31], v87
    v_exp_f32 v34, v34
    v_exp_f32 v35, v35
    v_exp_f32 v36, v36
    s_waitcnt lgkmcnt(3)
    v_mfma_f32_32x32x8_bf16 v[16:31], v[100:101], v[92:93], v[64:79]
    v_exp_f32 v37, v37
    v_exp_f32 v38, v38
    v_exp_f32 v39, v39
    v_exp_f32 v40, v40
    v_exp_f32 v41, v41
    s_waitcnt lgkmcnt(0)
    v_mfma_f32_32x32x16_bf16 v[16:31], v[96:99], v[88:91], v[16:31]
    ds_read_b128 v[96:99], v5 offset:1024
    v_exp_f32 v42, v42
    v_exp_f32 v43, v43
    v_exp_f32 v44, v44
    v_exp_f32 v45, v45
    v_smfmac_f32_32x32x32_bf16 v[48:63], v[104:107], v[32:39], v87
    s_mov_b64 exec, s[4:5]
    ds_read_b128 v[104:107], v7 offset:0
    ds_read_b128 v[108:111], v7 offset:320
    s_mov_b64 exec, -1
    v_exp_f32 v46, v46
    v_exp_f32 v47, v47
    s_sub_u32 s44, s44, 1
    s_cmp_lg_u32 s44, 0
    s_cbranch_scc1 L2_entry
    v_smfmac_f32_32x32x32_bf16 v[48:63], v[112:115], v[40:47], v87
    v_mov_b32 v116, 162048
    v_lshlrev_b32 v117, 3, v0
    s_setprio 0
    s_mov_b32 s69, 0
    s_mul_i32 s10, s18, 40960
    s_add_u32 s10, s10, 16777216
    s_lshl_b32 s45, s6, 10
    s_add_u32 s45, s45, s10
    s_lshl_b32 s47, s6, 8
    s_add_u32 s47, s47, s10
    s_add_u32 s47, s47, 32768
    s_mov_b32 s11, 0x67800000
    v_mov_b32 v10, v56
    v_mov_b32 v60, v56
    s_nop 1
    v_permlane32_swap_b32 v10, v60
L2_out:
    v_rcp_f32 v10, v60
    s_nop 0
    v_pk_mul_f32 v[48:49], v[48:49], v[10:11] op_sel_hi:[1,0]
    v_pk_mul_f32 v[50:51], v[50:51], v[10:11] op_sel_hi:[1,0]
    v_pk_mul_f32 v[52:53], v[52:53], v[10:11] op_sel_hi:[1,0]
    v_pk_mul_f32 v[54:55], v[54:55], v[10:11] op_sel_hi:[1,0]
    v_cvt_pk_bf16_f32 v80, v48, v49
    v_cvt_pk_bf16_f32 v81, v50, v51
    v_cvt_pk_bf16_f32 v82, v52, v53
    v_cvt_pk_bf16_f32 v83, v54, v55
    buffer_store_dwordx4 v[80:83], v2, s[24:27], s45 offen sc1
    v_pk_mul_f32 v[56:57], v[56:57], v[10:11] op_sel_hi:[1,0]
    v_pk_mul_f32 v[58:59], v[58:59], v[10:11] op_sel_hi:[1,0]
    v_cvt_pk_bf16_f32 v84, v56, v57
    v_cvt_pk_bf16_f32 v85, v58, v59
    s_mov_b32 exec_hi, 0
    buffer_store_dwordx2 v[84:85], v117, s[24:27], s47 offen sc1
    s_mov_b32 exec_hi, -1
    s_cmp_lg_u32 s69, 0
    s_cbranch_scc1 L2_ok
    s_mov_b32 s69, 1
    v_cmp_nle_f32 vcc, 0x35800000, v60
    v_cmp_nge_f32 s[66:67], s11, v60
    v_add_f32 v10, |v48|, |v49|
    v_add_f32 v11, |v50|, |v51|
    s_or_b64 s[66:67], vcc, s[66:67]
    v_add_f32 v10, v10, |v52|
    v_add_f32 v11, v11, |v53|
    v_add_f32 v10, v10, |v54|
    v_add_f32 v11, v11, |v55|
    v_add_f32 v10, v10, |v56|
    v_add_f32 v11, v11, |v57|
    v_add_f32 v10, v10, |v58|
    v_add_f32 v11, v11, |v59|
    v_add_f32 v10, v10, v11
    s_waitcnt lgkmcnt(0)
    v_cmp_nge_f32 vcc, 0x7e800000, v10
    s_or_b64 vcc, vcc, s[66:67]
    s_cbranch_vccnz L2_slow
L2_ok:
    ds_read_b32 v116, v116 offset:8
    v_and_b32 v7, 15, v0
    v_lshrrev_b32 v8, 4, v0
    v_lshlrev_b32 v5, 9, v8
    v_lshl_add_u32 v5, v7, 4, v5
    v_mul_u32_u24 v6, 656, v7
    v_lshl_add_u32 v6, v8, 4, v6
    s_lshr_b32 s10, s3, 2
    s_mul_i32 s11, s10, 12288
    v_add_u32 v5, s11, v5
    s_mul_i32 s10, s10, 20992
    s_lshl_b32 s11, s16, 6
    s_add_u32 s11, s11, s10
    s_add_u32 s11, s11, 40960
    v_add_u32 v6, s11, v6
    s_lshl_b32 s10, s18, 5
    s_add_u32 s10, s10, s6
    s_lshl_b32 s10, s10, 7
    s_add_u32 s10, s10, 22413312
    v_lshlrev_b32 v7, 2, v0
    s_barrier
    s_mov_b32 exec_hi, 0
    s_waitcnt vmcnt(0) lgkmcnt(0)
    buffer_store_dword v116, v7, s[24:27], s10 offen sc1
    s_mov_b32 exec_hi, -1
    s_cmp_ge_u32 s3, 2
    s_cbranch_scc1 L3_g0
    s_lshl_b32 s11, s3, 6
    s_add_u32 s11, s11, 512
    v_add_u32 v9, s11, v0
    v_mul_u32_u24 v10, 3277, v9
    v_lshrrev_b32 v10, 16, v10
    v_mul_u32_u24 v11, 20, v10
    v_sub_u32 v11, v9, v11
    v_mul_u32_u24 v9, 1280, v10
    v_lshl_add_u32 v9, v11, 4, v9
    buffer_load_dwordx4 v[36:39], v9, s[28:31], s17 offen
    s_lshl_b32 s11, s3, 6
    s_add_u32 s11, s11, 512
    v_add_u32 v7, s11, v0
    v_mul_u32_u24 v10, 3277, v7
    v_lshrrev_b32 v10, 16, v10
    v_mul_u32_u24 v11, 20, v10
    v_sub_u32 v11, v7, v11
    v_mul_u32_u24 v4, 656, v10
    v_lshl_add_u32 v4, v11, 5, v4
    v_add_u32 v7, 67584, v4
    v_cmp_gt_u32 vcc, 16, v11
    v_add_u32 v10, 82944, v4
    v_mov_b32 v11, 103936
    v_cndmask_b32 v33, v11, v10, vcc
    ds_read_b128 v[40:43], v7 offset:0
    ds_read_b128 v[44:47], v7 offset:16
    ds_read_b128 v[48:51], v7 offset:20992
    ds_read_b128 v[52:55], v7 offset:21008
    ds_read_b128 v[56:59], v7 offset:41984
    ds_read_b128 v[60:63], v7 offset:42000
    ds_read_b128 v[64:67], v7 offset:62976
    ds_read_b128 v[68:71], v7 offset:62992
    s_mov_b32 s11, 0xbfb8aa3b
    s_waitcnt lgkmcnt(0)
    v_add_f32 v40, v40, v48
    v_add_f32 v56, v56, v64
    v_add_f32 v41, v41, v49
    v_add_f32 v57, v57, v65
    v_add_f32 v42, v42, v50
    v_add_f32 v58, v58, v66
    v_add_f32 v43, v43, v51
    v_add_f32 v59, v59, v67
    v_add_f32 v44, v44, v52
    v_add_f32 v60, v60, v68
    v_add_f32 v45, v45, v53
    v_add_f32 v61, v61, v69
    v_add_f32 v46, v46, v54
    v_add_f32 v62, v62, v70
    v_add_f32 v47, v47, v55
    v_add_f32 v63, v63, v71
    v_add_f32 v40, v40, v56
    v_add_f32 v41, v41, v57
    v_add_f32 v42, v42, v58
    v_add_f32 v43, v43, v59
    v_add_f32 v44, v44, v60
    v_add_f32 v45, v45, v61
    v_add_f32 v46, v46, v62
    v_add_f32 v47, v47, v63
    v_mul_f32 v48, s11, v40
    v_mul_f32 v49, s11, v41
    v_mul_f32 v50, s11, v42
    v_mul_f32 v51, s11, v43
    v_mul_f32 v52, s11, v44
    v_mul_f32 v53, s11, v45
    v_mul_f32 v54, s11, v46
    v_mul_f32 v55, s11, v47
    v_exp_f32 v48, v48
    v_exp_f32 v49, v49
    v_exp_f32 v50, v50
    v_exp_f32 v51, v51
    v_exp_f32 v52, v52
    v_exp_f32 v53, v53
    v_exp_f32 v54, v54
    v_exp_f32 v55, v55
    v_add_f32 v48, 1.0, v48
    v_add_f32 v49, 1.0, v49
    v_add_f32 v50, 1.0, v50
    v_add_f32 v51, 1.0, v51
    v_add_f32 v52, 1.0, v52
    v_add_f32 v53, 1.0, v53
    v_add_f32 v54, 1.0, v54
    v_add_f32 v55, 1.0, v55
    v_rcp_f32 v48, v48
    v_rcp_f32 v49, v49
    v_rcp_f32 v50, v50
    v_rcp_f32 v51, v51
    v_rcp_f32 v52, v52
    v_rcp_f32 v53, v53
    v_rcp_f32 v54, v54
    v_rcp_f32 v55, v55
    v_mul_f32 v96, v40, v48
    v_mul_f32 v97, v41, v49
    v_mul_f32 v98, v42, v50
    v_mul_f32 v99, v43, v51
    v_mul_f32 v100, v44, v52
    v_mul_f32 v101, v45, v53
    v_mul_f32 v102, v46, v54
    v_mul_f32 v103, v47, v55
    s_waitcnt vmcnt(0)
    v_lshlrev_b32 v24, 16, v36
    v_and_b32 v25, 0xffff0000, v36
    v_lshlrev_b32 v26, 16, v37
    v_and_b32 v27, 0xffff0000, v37
    v_lshlrev_b32 v28, 16, v38
    v_and_b32 v29, 0xffff0000, v38
    v_lshlrev_b32 v30, 16, v39
    v_and_b32 v31, 0xffff0000, v39
L3_g0:
    s_lshl_b32 s11, s3, 6
    v_add_u32 v7, s11, v0
    v_mul_u32_u24 v10, 3277, v7
    v_lshrrev_b32 v10, 16, v10
    v_mul_u32_u24 v11, 20, v10
    v_sub_u32 v11, v7, v11
    v_mul_u32_u24 v3, 656, v10
    v_lshl_add_u32 v3, v11, 5, v3
    v_add_u32 v7, 67584, v3
    v_cmp_gt_u32 vcc, 16, v11
    v_add_u32 v10, 82944, v3
    v_mov_b32 v11, 103936
    v_cndmask_b32 v32, v11, v10, vcc
    ds_read_b128 v[40:43], v7 offset:0
    ds_read_b128 v[44:47], v7 offset:16
    ds_read_b128 v[48:51], v7 offset:20992
    ds_read_b128 v[52:55], v7 offset:21008
    ds_read_b128 v[56:59], v7 offset:41984
    ds_read_b128 v[60:63], v7 offset:42000
    ds_read_b128 v[64:67], v7 offset:62976
    ds_read_b128 v[68:71], v7 offset:62992
    s_mov_b32 s11, 0xbfb8aa3b
    s_waitcnt lgkmcnt(0)
    v_add_f32 v40, v40, v48
    v_add_f32 v56, v56, v64
    v_add_f32 v41, v41, v49
    v_add_f32 v57, v57, v65
    v_add_f32 v42, v42, v50
    v_add_f32 v58, v58, v66
    v_add_f32 v43, v43, v51
    v_add_f32 v59, v59, v67
    v_add_f32 v44, v44, v52
    v_add_f32 v60, v60, v68
    v_add_f32 v45, v45, v53
    v_add_f32 v61, v61, v69
    v_add_f32 v46, v46, v54
    v_add_f32 v62, v62, v70
    v_add_f32 v47, v47, v55
    v_add_f32 v63, v63, v71
    v_add_f32 v40, v40, v56
    v_add_f32 v41, v41, v57
    v_add_f32 v42, v42, v58
    v_add_f32 v43, v43, v59
    v_add_f32 v44, v44, v60
    v_add_f32 v45, v45, v61
    v_add_f32 v46, v46, v62
    v_add_f32 v47, v47, v63
    v_mul_f32 v48, s11, v40
    v_mul_f32 v49, s11, v41
    v_mul_f32 v50, s11, v42
    v_mul_f32 v51, s11, v43
    v_mul_f32 v52, s11, v44
    v_mul_f32 v53, s11, v45
    v_mul_f32 v54, s11, v46
    v_mul_f32 v55, s11, v47
    v_exp_f32 v48, v48
    v_exp_f32 v49, v49
    v_exp_f32 v50, v50
    v_exp_f32 v51, v51
    v_exp_f32 v52, v52
    v_exp_f32 v53, v53
    v_exp_f32 v54, v54
    v_exp_f32 v55, v55
    v_add_f32 v48, 1.0, v48
    v_add_f32 v49, 1.0, v49
    v_add_f32 v50, 1.0, v50
    v_add_f32 v51, 1.0, v51
    v_add_f32 v52, 1.0, v52
    v_add_f32 v53, 1.0, v53
    v_add_f32 v54, 1.0, v54
    v_add_f32 v55, 1.0, v55
    v_rcp_f32 v48, v48
    v_rcp_f32 v49, v49
    v_rcp_f32 v50, v50
    v_rcp_f32 v51, v51
    v_rcp_f32 v52, v52
    v_rcp_f32 v53, v53
    v_rcp_f32 v54, v54
    v_rcp_f32 v55, v55
    v_mul_f32 v88, v40, v48
    v_mul_f32 v89, v41, v49
    v_mul_f32 v90, v42, v50
    v_mul_f32 v91, v43, v51
    v_mul_f32 v92, v44, v52
    v_mul_f32 v93, v45, v53
    v_mul_f32 v94, v46, v54
    v_mul_f32 v95, v47, v55
    v_lshlrev_b32 v16, 16, v12
    v_and_b32 v17, 0xffff0000, v12
    v_lshlrev_b32 v18, 16, v13
    v_and_b32 v19, 0xffff0000, v13
    v_lshlrev_b32 v20, 16, v14
    v_and_b32 v21, 0xffff0000, v14
    v_lshlrev_b32 v22, 16, v15
    v_and_b32 v23, 0xffff0000, v15
    s_cmp_lt_u32 s3, 4
    s_barrier
    s_cbranch_scc1 L3_a
    s_barrier
L3_a:
    ds_read_b128 v[40:43], v5 offset:0
    ds_read_b128 v[44:47], v5 offset:256
    ds_read_b128 v[48:51], v5 offset:2048
    ds_read_b128 v[52:55], v5 offset:2304
    ds_read_b128 v[56:59], v5 offset:4096
    ds_read_b128 v[60:63], v5 offset:4352
    ds_read_b128 v[64:67], v5 offset:6144
    ds_read_b128 v[68:71], v5 offset:6400
    ds_read_b128 v[72:75], v5 offset:8192
    ds_read_b128 v[76:79], v5 offset:8448
    ds_read_b128 v[80:83], v5 offset:10240
    ds_read_b128 v[84:87], v5 offset:10496
    s_waitcnt lgkmcnt(10)
    v_mfma_f32_16x16x32_bf16 v[104:107], v[120:123], v[40:43], 0
    v_mfma_f32_16x16x32_bf16 v[112:115], v[124:127], v[40:43], 0
    v_mfma_f32_16x16x32_bf16 v[108:111], v[120:123], v[44:47], 0
    v_mfma_f32_16x16x32_bf16 v[116:119], v[124:127], v[44:47], 0
    s_waitcnt lgkmcnt(8)
    v_mfma_f32_16x16x32_bf16 v[104:107], v[128:131], v[48:51], v[104:107]
    v_mfma_f32_16x16x32_bf16 v[112:115], v[132:135], v[48:51], v[112:115]
    v_mfma_f32_16x16x32_bf16 v[108:111], v[128:131], v[52:55], v[108:111]
    v_mfma_f32_16x16x32_bf16 v[116:119], v[132:135], v[52:55], v[116:119]
    s_waitcnt lgkmcnt(6)
    v_mfma_f32_16x16x32_bf16 v[104:107], v[136:139], v[56:59], v[104:107]
    v_mfma_f32_16x16x32_bf16 v[112:115], v[140:143], v[56:59], v[112:115]
    v_mfma_f32_16x16x32_bf16 v[108:111], v[136:139], v[60:63], v[108:111]
    v_mfma_f32_16x16x32_bf16 v[116:119], v[140:143], v[60:63], v[116:119]
    s_waitcnt lgkmcnt(4)
    v_mfma_f32_16x16x32_bf16 v[104:107], v[144:147], v[64:67], v[104:107]
    v_mfma_f32_16x16x32_bf16 v[112:115], v[148:151], v[64:67], v[112:115]
    v_mfma_f32_16x16x32_bf16 v[108:111], v[144:147], v[68:71], v[108:111]
    v_mfma_f32_16x16x32_bf16 v[116:119], v[148:151], v[68:71], v[116:119]
    s_cbranch_scc0 L3_b
    s_barrier
L3_b:
    s_waitcnt lgkmcnt(2)
    v_mfma_f32_16x16x32_bf16 v[104:107], v[152:155], v[72:75], v[104:107]
    v_mfma_f32_16x16x32_bf16 v[112:115], v[156:159], v[72:75], v[112:115]
    v_mfma_f32_16x16x32_bf16 v[108:111], v[152:155], v[76:79], v[108:111]
    v_mfma_f32_16x16x32_bf16 v[116:119], v[156:159], v[76:79], v[116:119]
    s_waitcnt lgkmcnt(0)
    v_mfma_f32_16x16x32_bf16 v[104:107], v[160:163], v[80:83], v[104:107]
    v_mfma_f32_16x16x32_bf16 v[112:115], v[164:167], v[80:83], v[112:115]
    v_mfma_f32_16x16x32_bf16 v[108:111], v[160:163], v[84:87], v[108:111]
    v_mfma_f32_16x16x32_bf16 v[116:119], v[164:167], v[84:87], v[116:119]
    s_nop 4
    ds_write_b128 v6, v[104:107] offset:0
    ds_write_b128 v6, v[112:115] offset:256
    ds_write_b128 v6, v[108:111] offset:10496
    ds_write_b128 v6, v[116:119] offset:10752
    s_waitcnt lgkmcnt(0)
    s_barrier
    ds_read_b128 v[40:43], v3 offset:40960
    ds_read_b128 v[44:47], v3 offset:40976
    ds_read_b128 v[48:51], v3 offset:61952
    ds_read_b128 v[52:55], v3 offset:61968
    ds_read_b128 v[56:59], v32 offset:0
    ds_read_b128 v[60:63], v32 offset:16
    s_cmp_ge_u32 s3, 2
    s_cbranch_scc1 L3_f0
    ds_read_b128 v[64:67], v4 offset:40960
    ds_read_b128 v[68:71], v4 offset:40976
    ds_read_b128 v[72:75], v4 offset:61952
    ds_read_b128 v[76:79], v4 offset:61968
    ds_read_b128 v[80:83], v33 offset:0
    ds_read_b128 v[84:87], v33 offset:16
    s_waitcnt lgkmcnt(0)
    v_pk_add_f32 v[64:65], v[64:65], v[72:73]
    v_pk_add_f32 v[66:67], v[66:67], v[74:75]
    v_pk_add_f32 v[68:69], v[68:69], v[76:77]
    v_pk_add_f32 v[70:71], v[70:71], v[78:79]
    v_pk_add_f32 v[64:65], v[64:65], v[80:81]
    v_pk_add_f32 v[66:67], v[66:67], v[82:83]
    v_pk_add_f32 v[68:69], v[68:69], v[84:85]
    v_pk_add_f32 v[70:71], v[70:71], v[86:87]
    v_pk_fma_f32 v[24:25], v[64:65], v[96:97], v[24:25]
    v_pk_fma_f32 v[26:27], v[66:67], v[98:99], v[26:27]
    v_pk_fma_f32 v[28:29], v[68:69], v[100:101], v[28:29]
    v_pk_fma_f32 v[30:31], v[70:71], v[102:103], v[30:31]
    v_cvt_pk_bf16_f32 v36, v24, v25
    v_cvt_pk_bf16_f32 v37, v26, v27
    v_cvt_pk_bf16_f32 v38, v28, v29
    v_cvt_pk_bf16_f32 v39, v30, v31
    buffer_store_dwordx4 v[36:39], v9, s[32:35], s17 offen sc1
L3_f0:
    s_waitcnt lgkmcnt(0)
    v_pk_add_f32 v[40:41], v[40:41], v[48:49]
    v_pk_add_f32 v[42:43], v[42:43], v[50:51]
    v_pk_add_f32 v[44:45], v[44:45], v[52:53]
    v_pk_add_f32 v[46:47], v[46:47], v[54:55]
    v_pk_add_f32 v[40:41], v[40:41], v[56:57]
    v_pk_add_f32 v[42:43], v[42:43], v[58:59]
    v_pk_add_f32 v[44:45], v[44:45], v[60:61]
    v_pk_add_f32 v[46:47], v[46:47], v[62:63]
    v_pk_fma_f32 v[16:17], v[40:41], v[88:89], v[16:17]
    v_pk_fma_f32 v[18:19], v[42:43], v[90:91], v[18:19]
    v_pk_fma_f32 v[20:21], v[44:45], v[92:93], v[20:21]
    v_pk_fma_f32 v[22:23], v[46:47], v[94:95], v[22:23]
    v_cvt_pk_bf16_f32 v12, v16, v17
    v_cvt_pk_bf16_f32 v13, v18, v19
    v_cvt_pk_bf16_f32 v14, v20, v21
    v_cvt_pk_bf16_f32 v15, v22, v23
    buffer_store_dwordx4 v[12:15], v1, s[32:35], s17 offen sc1
L3_done:
    s_endpgm
L2_slow:
    s_lshl_b32 s66, s9, 9
    s_add_u32 s66, s66, 2662400
    s_lshl_b32 s67, s12, 9
    s_add_u32 s67, s67, 2662400
    s_mov_b32 s68, 7864320
    s_mov_b32 s44, 64
    v_mov_b32 v9, 0xff800000
L2_s1:
    buffer_load_dwordx4 v[96:99], v2, s[24:27], s66 offen sc1
    buffer_load_dwordx2 v[100:101], v8, s[24:27], s67 offen sc1
    s_add_u32 s66, s66, 81920
    s_add_u32 s67, s67, 81920
    s_waitcnt vmcnt(0)
    v_mfma_f32_32x32x8_bf16 v[16:31], v[100:101], v[92:93], 0
    v_mfma_f32_32x32x16_bf16 v[16:31], v[96:99], v[88:91], v[16:31]
    s_nop 15
    v_max3_f32 v10, v16, v17, v18
    v_max3_f32 v11, v19, v20, v21
    v_max3_f32 v10, v10, v22, v23
    v_max3_f32 v11, v11, v24, v25
    v_max3_f32 v10, v10, v26, v27
    v_max3_f32 v11, v11, v28, v29
    v_max3_f32 v10, v10, v30, v31
    v_max3_f32 v9, v10, v11, v9
    s_sub_u32 s44, s44, 1
    s_cmp_lg_u32 s44, 0
    s_cbranch_scc1 L2_s1
    v_mov_b32 v10, v9
    s_nop 1
    v_permlane32_swap_b32 v10, v9
    s_nop 0
    v_max_f32 v9, v10, v9
    s_lshl_b32 s66, s9, 9
    s_add_u32 s66, s66, 2662400
    s_lshl_b32 s67, s12, 9
    s_add_u32 s67, s67, 2662400
    s_mov_b32 s68, 7864320
    s_mov_b32 s44, 64
    v_mov_b32 v48, 0
    v_mov_b32 v49, 0
    v_mov_b32 v50, 0
    v_mov_b32 v51, 0
    v_mov_b32 v52, 0
    v_mov_b32 v53, 0
    v_mov_b32 v54, 0
    v_mov_b32 v55, 0
    v_mov_b32 v56, 0
    v_mov_b32 v57, 0
    v_mov_b32 v58, 0
    v_mov_b32 v59, 0
    v_mov_b32 v60, 0
    v_mov_b32 v61, 0
    v_mov_b32 v62, 0
    v_mov_b32 v63, 0
    v_lshrrev_b32 v10, 5, v0
    v_mul_u32_u24 v11, 40, v10
    v_lshrrev_b32 v4, 4, v4
    v_sub_u32 v4, v4, v11
    s_mul_i32 s10, s6, 20
    v_add_u32 v4, s10, v4
    v_lshrrev_b32 v11, 4, v4
    v_and_b32 v4, 15, v4
    v_lshlrev_b32 v4, 4, v4
    v_lshl_add_u32 v4, v11, 16, v4
    v_lshl_add_u32 v4, v10, 9, v4
L2_s2:
    s_mov_b64 exec, s[4:5]
    buffer_load_dwordx4 v[104:107], v4, s[24:27], s68 offen sc1
    buffer_load_dwordx4 v[108:111], v4, s[24:27], s68 offen offset:256 sc1
    s_mov_b64 exec, -1
    s_add_u32 s68, s68, 1024
    buffer_load_dwordx4 v[96:99], v2, s[24:27], s66 offen sc1
    buffer_load_dwordx2 v[100:101], v8, s[24:27], s67 offen sc1
    s_add_u32 s66, s66, 81920
    s_add_u32 s67, s67, 81920
    s_waitcnt vmcnt(0)
    v_mfma_f32_32x32x8_bf16 v[16:31], v[100:101], v[92:93], 0
    v_mfma_f32_32x32x16_bf16 v[16:31], v[96:99], v[88:91], v[16:31]
    s_nop 15
    v_sub_f32 v16, v16, v9
    v_sub_f32 v17, v17, v9
    v_sub_f32 v18, v18, v9
    v_sub_f32 v19, v19, v9
    v_sub_f32 v20, v20, v9
    v_sub_f32 v21, v21, v9
    v_sub_f32 v22, v22, v9
    v_sub_f32 v23, v23, v9
    v_sub_f32 v24, v24, v9
    v_sub_f32 v25, v25, v9
    v_sub_f32 v26, v26, v9
    v_sub_f32 v27, v27, v9
    v_sub_f32 v28, v28, v9
    v_sub_f32 v29, v29, v9
    v_sub_f32 v30, v30, v9
    v_sub_f32 v31, v31, v9
    v_exp_f32 v16, v16
    v_exp_f32 v17, v17
    v_exp_f32 v18, v18
    v_exp_f32 v19, v19
    v_exp_f32 v20, v20
    v_exp_f32 v21, v21
    v_exp_f32 v22, v22
    v_exp_f32 v23, v23
    v_exp_f32 v24, v24
    v_exp_f32 v25, v25
    v_exp_f32 v26, v26
    v_exp_f32 v27, v27
    v_exp_f32 v28, v28
    v_exp_f32 v29, v29
    v_exp_f32 v30, v30
    v_exp_f32 v31, v31
    s_nop 1
    v_smfmac_f32_32x32x32_bf16 v[48:63], v[104:107], v[16:23], v87
    v_smfmac_f32_32x32x32_bf16 v[48:63], v[108:111], v[24:31], v87
    s_sub_u32 s44, s44, 1
    s_cmp_lg_u32 s44, 0
    s_cbranch_scc1 L2_s2
    s_nop 15
    v_mov_b32 v10, v56
    v_mov_b32 v60, v56
    s_nop 1
    v_permlane32_swap_b32 v10, v60
    s_branch L2_out
L1_csw:
    s_mov_b32 s10, 2097152
L1_csb:
    ds_read_b32 v128, v126 offset:28
    s_sub_u32 s10, s10, 1
    s_waitcnt lgkmcnt(0)
    v_cmp_gt_u32 vcc, 4, v128
    s_cbranch_scc1 L1_csb_x
    s_cbranch_vccnz L1_csb
L1_csb_x:
    s_branch L1_csr
L_codeend:
.section .rodata,"a"
.p2align 6
.amdhsa_kernel recurrent_scan__softmax_full_mha__swiglu_ffn__prompt_kernel
  .amdhsa_next_free_vgpr 168
  .amdhsa_next_free_sgpr 72
  .amdhsa_accum_offset 168
  .amdhsa_group_segment_fixed_size 0
  .amdhsa_kernarg_size 80
  .amdhsa_user_sgpr_count 2
  .amdhsa_user_sgpr_kernarg_segment_ptr 1
  .amdhsa_system_sgpr_workgroup_id_x 1
.end_amdhsa_kernel
```
